```python
import torch

def _softmax(x, axis=-1):
    return torch.softmax(x, dim=axis)
def _gelu(x):
    return torch.nn.functional.gelu(x, approximate="tanh")
def _silu(x):
    return torch.nn.functional.silu(x)
def _sigmoid(x):
    return torch.sigmoid(x)
def _layernorm(x, axis=-1, eps=1e-5):
    m = x.mean(dim=axis, keepdim=True)
    v = x.var(dim=axis, keepdim=True, unbiased=False)
    return (x - m) / torch.sqrt(v + eps)
def _scatter_add(tgt, idx, src, axis=0):
    return tgt.clone().index_add_(axis, idx, src)
def _segment_sum(src, seg, n):
    out = torch.zeros((n,) + src.shape[1:], dtype=src.dtype)
    return out.index_add_(0, seg, src)
def _pad(x, pw):
    flat = tuple(v for pair in reversed(pw) for v in pair)
    return torch.nn.functional.pad(x, flat)

kernel_name = 'standalone__gqa_block_cached__near_ridge'

def setup_inputs():

    _w = (lambda a: (lambda t: t.to(torch.bfloat16) if t.is_floating_point() else t)(torch.as_tensor(a)))
    B, Sq, D = 8, 96, 512
    Hq, Hkv, Sk, Dh = 32, 32, 512, 128
    assert Hq % Hkv == 0, (Hq, Hkv)
    return {
        "x": _w((lambda *s: torch.randn(*s, dtype=torch.bfloat16) * 0.8)(B, Sq, D)),
        "k_cache": _w((lambda *s: torch.randn(*s, dtype=torch.bfloat16) * 0.8)(B, Hkv, Sk, Dh)),
        "v_cache": _w((lambda *s: torch.randn(*s, dtype=torch.bfloat16) * 0.05)(B, Hkv, Sk, Dh)),
        "wq": _w((lambda *s: torch.randn(*s, dtype=torch.bfloat16) * 0.8)(D, Hq * Dh) * (D ** -0.5)),
        "wo": _w((lambda *s: torch.randn(*s, dtype=torch.bfloat16) * 0.05)(Hq * Dh, D) * ((Hq * Dh) ** -0.5)),
    }

def reference(x, k_cache, v_cache, wq, wo):
    B, Sq, D = x.shape
    Hq, Dh = 32, 128
    Hkv = k_cache.shape[1]
    rep = Hq // Hkv
    q = (lambda x, *d: x.permute(*d))((x @ wq).reshape(B, Sq, Hq, Dh), 0, 2, 1, 3)
    k = (lambda x, n, axis: torch.repeat_interleave(x, n, dim=axis))(k_cache, rep, axis=1)
    v = (lambda x, n, axis: torch.repeat_interleave(x, n, dim=axis))(v_cache, rep, axis=1)
    scores = torch.einsum("bhqd,bhkd->bhqk", q, k) * (Dh ** -0.5)
    p = _softmax(scores, axis=-1)
    o = torch.einsum("bhqk,bhkd->bhqd", p, v)
    return (lambda x, *d: x.permute(*d))(o, 0, 2, 1, 3).reshape(B, Sq, Hq * Dh) @ wo
```

```asm
; @launch grid=(256,1,1) block=(256,1,1) lds=163840
.amdgcn_target "amdgcn-amd-amdhsa--gfx950"
.text
.globl standalone__gqa_block_cached__near_ridge_kernel
.p2align 8
.type standalone__gqa_block_cached__near_ridge_kernel,@function
standalone__gqa_block_cached__near_ridge_kernel:
    s_cmp_ge_u32 s2, 256
    s_cbranch_scc1 L_end
    s_load_dwordx16 s[56:71], s[0:1], 0
    s_memrealtime s[6:7]
    v_and_b32 v1, 63, v0
    v_lshrrev_b32 v30, 6, v0
    s_nop 0
    v_readfirstlane_b32 s40, v30
    s_and_b32 s43, s2, 7
    s_lshr_b32 s44, s2, 3
    s_and_b32 s45, s44, 3
    s_lshl_b32 s42, s43, 2
    s_add_u32 s42, s42, s45
    s_lshr_b32 s41, s44, 2
    s_and_b32 s5, s43, 1
    s_andn2_b32 s50, s43, 1
    s_lshr_b32 s46, s45, 1
    s_add_u32 s50, s50, s46
    s_and_b32 s51, s45, 1
    s_mov_b32 s52, s41
    s_lshl_b32 s4, s45, 1
    s_add_u32 s4, s4, s52
    s_lshl_b32 s4, s4, 1
    s_and_b32 s4, s4, 15
    s_lshl_b32 s47, s41, 5
    s_add_u32 s47, s47, s42
    s_lshl_b32 s47, s47, 17
    s_lshl_b32 s46, s40, 15
    s_add_u32 s47, s47, s46
    s_mul_i32 s48, s41, 98304
    s_add_u32 s54, s40, 1
    s_and_b32 s54, s54, 3
    s_mov_b32 s49, 0x3e0293ee
    v_and_b32 v30, 15, v1
    v_lshrrev_b32 v31, 4, v1
    v_lshlrev_b32 v2, 8, v30
    v_lshl_add_u32 v2, v31, 4, v2
    v_lshlrev_b32 v8, 4, v1
    s_waitcnt lgkmcnt(0)
    s_or_b32 s6, s6, 1
    s_add_u32 s7, s41, s42
    s_mov_b32 s8, s56
    s_and_b32 s9, s57, 0xffff
    s_mov_b32 s10, 786432
    s_mov_b32 s11, 0x00020000
    s_mov_b32 s12, s58
    s_and_b32 s13, s59, 0xffff
    s_mov_b32 s14, 33554432
    s_mov_b32 s15, 0x00020000
    s_mov_b32 s16, s60
    s_and_b32 s17, s61, 0xffff
    s_mov_b32 s18, 33554432
    s_mov_b32 s19, 0x00020000
    s_mov_b32 s20, s62
    s_and_b32 s21, s63, 0xffff
    s_mov_b32 s22, 4194304
    s_mov_b32 s23, 0x00020000
    s_mov_b32 s24, s64
    s_and_b32 s25, s65, 0xffff
    s_mov_b32 s26, 4194304
    s_mov_b32 s27, 0x00020000
    s_mov_b32 s28, s66
    s_and_b32 s29, s67, 0xffff
    s_mov_b32 s30, 786432
    s_mov_b32 s31, 0x00020000
    s_mov_b32 s36, s68
    s_and_b32 s37, s69, 0xffff
    s_mov_b32 s38, 256
    s_mov_b32 s39, 0x00020000
    s_mov_b32 s32, s70
    s_and_b32 s33, s71, 0xffff
    s_mov_b32 s34, 16777216
    s_mov_b32 s35, 0x00020000
    s_lshl_b32 s44, s40, 2
    v_lshrrev_b32 v30, 4, v1
    v_add_u32 v30, s44, v30
    v_xor_b32 v29, v30, v1
    v_and_b32 v29, 15, v29
    v_lshlrev_b32 v31, 10, v30
    v_lshl_add_u32 v31, v29, 4, v31
    s_lshl_b32 s59, s40, 10
    v_lshrrev_b32 v30, 4, v1
    v_lshlrev_b32 v7, 13, v30
    v_and_b32 v30, 15, v1
    v_lshl_add_u32 v7, v30, 4, v7
    s_lshl_b32 s61, s42, 8
    s_lshl_b32 s44, s40, 18
    s_add_u32 s61, s61, s44
    s_or_b32 s43, s2, s40
    s_cmp_lg_u32 s43, 0
    s_cbranch_scc1 L_notag
    v_mov_b32 v122, s6
    v_mov_b32 v123, 0
    s_mov_b64 exec, 1
    buffer_store_dword v122, v123, s[36:39], 0 offen sc1
    s_mov_b64 exec, -1
L_notag:
    s_add_u32 s63, s7, 0
    s_mov_b32 s63, 0
    s_lshl_b32 s64, s63, 20
    s_add_u32 s64, s64, s61
    s_lshl_b32 s63, s63, 8
    s_add_u32 s63, s63, s48
    s_add_u32 m0, s59, 0
    s_add_u32 s60, s63, 0
    buffer_load_dwordx4 v31, s[8:11], s60 offen lds
    s_add_u32 m0, s59, 4096
    s_add_u32 s60, s63, 16384
    buffer_load_dwordx4 v31, s[8:11], s60 offen lds
    s_add_u32 m0, s59, 8192
    s_add_u32 s60, s63, 32768
    buffer_load_dwordx4 v31, s[8:11], s60 offen lds
    s_add_u32 m0, s59, 12288
    s_add_u32 s60, s63, 49152
    buffer_load_dwordx4 v31, s[8:11], s60 offen lds
    s_add_u32 m0, s59, 16384
    s_add_u32 s60, s63, 65536
    buffer_load_dwordx4 v31, s[8:11], s60 offen lds
    s_add_u32 m0, s59, 20480
    s_add_u32 s60, s63, 81920
    buffer_load_dwordx4 v31, s[8:11], s60 offen lds
    s_add_u32 s60, s64, 0
    buffer_load_dwordx4 a[128:131], v7, s[20:23], s60 offen
    s_add_u32 s60, s64, 32768
    buffer_load_dwordx4 a[132:135], v7, s[20:23], s60 offen
    s_add_u32 s60, s64, 65536
    buffer_load_dwordx4 a[136:139], v7, s[20:23], s60 offen
    s_add_u32 s60, s64, 98304
    buffer_load_dwordx4 a[140:143], v7, s[20:23], s60 offen
    s_add_u32 s60, s64, 131072
    buffer_load_dwordx4 a[144:147], v7, s[20:23], s60 offen
    s_add_u32 s60, s64, 163840
    buffer_load_dwordx4 a[148:151], v7, s[20:23], s60 offen
    s_add_u32 s60, s64, 196608
    buffer_load_dwordx4 a[152:155], v7, s[20:23], s60 offen
    s_add_u32 s60, s64, 229376
    buffer_load_dwordx4 a[156:159], v7, s[20:23], s60 offen
    v_mov_b32 v121, v31
    s_lshl_b32 s44, s40, 14
    s_add_u32 s44, s44, 98304
    v_bfe_u32 v30, v1, 2, 2
    v_lshlrev_b32 v9, 14, v30
    v_lshrrev_b32 v30, 4, v1
    v_lshl_add_u32 v9, v30, 6, v9
    v_and_b32 v30, 3, v1
    v_lshl_add_u32 v9, v30, 4, v9
    s_lshl_b32 s45, s40, 11
    s_add_u32 s45, s45, 98304
    v_add_u32 v9, s45, v9
    v_lshrrev_b32 v30, 5, v1
    v_lshlrev_b32 v30, 3, v30
    v_bfe_u32 v31, v1, 2, 2
    v_add_u32 v30, v30, v31
    v_lshlrev_b32 v10, 6, v30
    v_bfe_u32 v30, v1, 4, 1
    v_lshl_add_u32 v10, v30, 5, v10
    v_and_b32 v30, 1, v1
    v_lshl_add_u32 v10, v30, 4, v10
    v_bfe_u32 v30, v1, 1, 1
    v_lshl_add_u32 v10, v30, 3, v10
    v_add_u32 v10, s44, v10
    v_and_b32 v30, 31, v1
    v_lshlrev_b32 v30, 8, v30
    v_lshrrev_b32 v31, 5, v1
    v_add_u32 v11, 0, v31
    v_xor_b32 v11, v11, v1
    v_and_b32 v11, 15, v11
    v_lshl_add_u32 v11, v11, 4, v30
    v_add_u32 v112, 0xc000, v11
    v_add_u32 v12, 2, v31
    v_xor_b32 v12, v12, v1
    v_and_b32 v12, 15, v12
    v_lshl_add_u32 v12, v12, 4, v30
    v_add_u32 v113, 0xc000, v12
    v_add_u32 v13, 4, v31
    v_xor_b32 v13, v13, v1
    v_and_b32 v13, 15, v13
    v_lshl_add_u32 v13, v13, 4, v30
    v_add_u32 v114, 0xc000, v13
    v_add_u32 v14, 6, v31
    v_xor_b32 v14, v14, v1
    v_and_b32 v14, 15, v14
    v_lshl_add_u32 v14, v14, 4, v30
    v_add_u32 v115, 0xc000, v14
    v_add_u32 v15, 8, v31
    v_xor_b32 v15, v15, v1
    v_and_b32 v15, 15, v15
    v_lshl_add_u32 v15, v15, 4, v30
    v_add_u32 v116, 0xc000, v15
    v_add_u32 v16, 10, v31
    v_xor_b32 v16, v16, v1
    v_and_b32 v16, 15, v16
    v_lshl_add_u32 v16, v16, 4, v30
    v_add_u32 v117, 0xc000, v16
    v_add_u32 v17, 12, v31
    v_xor_b32 v17, v17, v1
    v_and_b32 v17, 15, v17
    v_lshl_add_u32 v17, v17, 4, v30
    v_add_u32 v118, 0xc000, v17
    v_add_u32 v18, 14, v31
    v_xor_b32 v18, v18, v1
    v_and_b32 v18, 15, v18
    v_lshl_add_u32 v18, v18, 4, v30
    v_add_u32 v119, 0xc000, v18
    v_bfe_u32 v30, v1, 4, 1
    v_lshlrev_b32 v19, 12, v30
    v_and_b32 v30, 15, v1
    v_lshl_add_u32 v19, v30, 4, v19
    v_lshrrev_b32 v30, 5, v1
    v_lshl_add_u32 v19, v30, 8, v19
    s_lshl_b32 s44, s40, 10
    s_add_u32 s44, s44, 131072
    v_add_u32 v19, s44, v19
    v_lshrrev_b32 v30, 4, v1
    v_lshlrev_b32 v30, 1, v30
    v_xor_b32 v30, v30, v1
    v_and_b32 v30, 7, v30
    v_lshrrev_b32 v120, 3, v1
    v_lshlrev_b32 v20, 8, v120
    v_lshl_add_u32 v20, v30, 4, v20
    v_and_b32 v30, 7, v1
    v_lshlrev_b32 v29, 10, v120
    v_lshl_add_u32 v29, v30, 4, v29
    v_lshrrev_b32 v30, 2, v1
    v_lshlrev_b32 v21, 7, v30
    v_bfe_u32 v30, v1, 3, 2
    v_lshl_add_u32 v21, v30, 5, v21
    v_and_b32 v30, 3, v1
    v_lshl_add_u32 v21, v30, 3, v21
    s_lshl_b32 s57, s40, 15
    v_add_u32 v21, s57, v21
    s_and_b32 s44, s40, 1
    s_lshl_b32 s44, s44, 6
    v_xor_b32 v23, s44, v21
    v_xor_b32 v24, 32, v23
    v_xor_b32 v21, 64, v23
    v_xor_b32 v22, 64, v24
    v_add_u32 v25, s57, v8
    s_lshl_b32 s44, s40, 13
    s_add_u32 s44, s44, 131072
    v_add_u32 v26, s44, v8
    v_xor_b32 v3, 0x18000, v25
    v_xor_b32 v4, 0x10000, v25
    v_xor_b32 v5, 0x4000, v26
    v_xor_b32 v6, 0x8000, v25
    s_lshl_b32 s58, s52, 3
    s_lshl_b32 s44, s5, 2
    s_add_u32 s58, s58, s44
    s_add_u32 s58, s58, s40
    s_lshl_b32 s58, s58, 16
    s_add_u32 s58, s58, 12582912
    v_and_b32 v30, 15, v1
    v_lshlrev_b32 v28, 4, v30
    v_add_u32 v28, 155648, v28
    s_lshl_b32 s44, s40, 2
    v_add_u32 v27, s44, v28
    s_add_u32 s63, s7, 1
    s_mov_b32 s63, 1
    s_lshl_b32 s64, s63, 20
    s_add_u32 s64, s64, s61
    s_lshl_b32 s63, s63, 8
    s_add_u32 s63, s63, s48
    s_add_u32 m0, s59, 24576
    s_add_u32 s60, s63, 0
    buffer_load_dwordx4 v121, s[8:11], s60 offen lds
    s_add_u32 m0, s59, 28672
    s_add_u32 s60, s63, 16384
    buffer_load_dwordx4 v121, s[8:11], s60 offen lds
    s_add_u32 m0, s59, 32768
    s_add_u32 s60, s63, 32768
    buffer_load_dwordx4 v121, s[8:11], s60 offen lds
    s_add_u32 m0, s59, 36864
    s_add_u32 s60, s63, 49152
    buffer_load_dwordx4 v121, s[8:11], s60 offen lds
    s_add_u32 m0, s59, 40960
    s_add_u32 s60, s63, 65536
    buffer_load_dwordx4 v121, s[8:11], s60 offen lds
    s_add_u32 m0, s59, 45056
    s_add_u32 s60, s63, 81920
    buffer_load_dwordx4 v121, s[8:11], s60 offen lds
    s_add_u32 s60, s64, 0
    buffer_load_dwordx4 a[160:163], v7, s[20:23], s60 offen
    s_add_u32 s60, s64, 32768
    buffer_load_dwordx4 a[164:167], v7, s[20:23], s60 offen
    s_add_u32 s60, s64, 65536
    buffer_load_dwordx4 a[168:171], v7, s[20:23], s60 offen
    s_add_u32 s60, s64, 98304
    buffer_load_dwordx4 a[172:175], v7, s[20:23], s60 offen
    s_add_u32 s60, s64, 131072
    buffer_load_dwordx4 a[176:179], v7, s[20:23], s60 offen
    s_add_u32 s60, s64, 163840
    buffer_load_dwordx4 a[180:183], v7, s[20:23], s60 offen
    s_add_u32 s60, s64, 196608
    buffer_load_dwordx4 a[184:187], v7, s[20:23], s60 offen
    s_add_u32 s60, s64, 229376
    buffer_load_dwordx4 a[188:191], v7, s[20:23], s60 offen
    s_waitcnt vmcnt(14)
    ds_write_b128 v9, a[128:131] offset:0
    ds_write_b128 v9, a[132:135] offset:256
    ds_write_b128 v9, a[136:139] offset:512
    ds_write_b128 v9, a[140:143] offset:768
    ds_write_b128 v9, a[144:147] offset:1024
    ds_write_b128 v9, a[148:151] offset:1280
    ds_write_b128 v9, a[152:155] offset:1536
    ds_write_b128 v9, a[156:159] offset:1792
    s_waitcnt lgkmcnt(0)
    s_barrier
    ds_read_b64_tr_b16 v[164:165], v10 offset:0
    ds_read_b64_tr_b16 v[166:167], v10 offset:256
    ds_read_b128 v[128:131], v11 offset:0
    ds_read_b128 v[132:135], v11 offset:8192
    ds_read_b128 v[136:139], v11 offset:16384
    ds_read_b64_tr_b16 v[168:169], v10 offset:1024
    ds_read_b64_tr_b16 v[170:171], v10 offset:1280
    ds_read_b128 v[140:143], v12 offset:0
    ds_read_b128 v[144:147], v12 offset:8192
    ds_read_b128 v[148:151], v12 offset:16384
    ds_read_b64_tr_b16 v[172:173], v10 offset:2048
    ds_read_b64_tr_b16 v[174:175], v10 offset:2304
    ds_read_b128 v[152:155], v13 offset:0
    ds_read_b128 v[156:159], v13 offset:8192
    ds_read_b128 v[160:163], v13 offset:16384
    s_waitcnt lgkmcnt(10)
    v_mfma_f32_32x32x16_bf16 v[32:47], v[164:167], v[128:131], 0
    s_add_u32 s63, s7, 2
    s_mov_b32 s63, 2
    s_lshl_b32 s64, s63, 20
    s_add_u32 s64, s64, s61
    s_lshl_b32 s63, s63, 8
    s_add_u32 s63, s63, s48
    s_add_u32 m0, s59, 49152
    s_add_u32 s60, s63, 0
    buffer_load_dwordx4 v121, s[8:11], s60 offen lds
    v_mfma_f32_32x32x16_bf16 v[48:63], v[164:167], v[132:135], 0
    s_add_u32 m0, s59, 53248
    s_add_u32 s60, s63, 16384
    buffer_load_dwordx4 v121, s[8:11], s60 offen lds
    v_mfma_f32_32x32x16_bf16 v[64:79], v[164:167], v[136:139], 0
    s_add_u32 m0, s59, 57344
    s_add_u32 s60, s63, 32768
    buffer_load_dwordx4 v121, s[8:11], s60 offen lds
    ds_read_b64_tr_b16 v[164:165], v10 offset:3072
    ds_read_b64_tr_b16 v[166:167], v10 offset:3328
    ds_read_b128 v[128:131], v14 offset:0
    ds_read_b128 v[132:135], v14 offset:8192
    ds_read_b128 v[136:139], v14 offset:16384
    s_waitcnt lgkmcnt(10)
    v_mfma_f32_32x32x16_bf16 v[32:47], v[168:171], v[140:143], v[32:47]
    s_add_u32 m0, s59, 61440
    s_add_u32 s60, s63, 49152
    buffer_load_dwordx4 v121, s[8:11], s60 offen lds
    v_mfma_f32_32x32x16_bf16 v[48:63], v[168:171], v[144:147], v[48:63]
    s_add_u32 m0, s59, 65536
    s_add_u32 s60, s63, 65536
    buffer_load_dwordx4 v121, s[8:11], s60 offen lds
    v_mfma_f32_32x32x16_bf16 v[64:79], v[168:171], v[148:151], v[64:79]
    s_add_u32 m0, s59, 69632
    s_add_u32 s60, s63, 81920
    buffer_load_dwordx4 v121, s[8:11], s60 offen lds
    ds_read_b64_tr_b16 v[168:169], v10 offset:4096
    ds_read_b64_tr_b16 v[170:171], v10 offset:4352
    ds_read_b128 v[140:143], v15 offset:0
    ds_read_b128 v[144:147], v15 offset:8192
    ds_read_b128 v[148:151], v15 offset:16384
    s_waitcnt lgkmcnt(10)
    v_mfma_f32_32x32x16_bf16 v[32:47], v[172:175], v[152:155], v[32:47]
    s_add_u32 s60, s64, 0
    buffer_load_dwordx4 a[192:195], v7, s[20:23], s60 offen
    v_mfma_f32_32x32x16_bf16 v[48:63], v[172:175], v[156:159], v[48:63]
    s_add_u32 s60, s64, 32768
    buffer_load_dwordx4 a[196:199], v7, s[20:23], s60 offen
    v_mfma_f32_32x32x16_bf16 v[64:79], v[172:175], v[160:163], v[64:79]
    s_add_u32 s60, s64, 65536
    buffer_load_dwordx4 a[200:203], v7, s[20:23], s60 offen
    ds_read_b64_tr_b16 v[172:173], v10 offset:5120
    ds_read_b64_tr_b16 v[174:175], v10 offset:5376
    ds_read_b128 v[152:155], v16 offset:0
    ds_read_b128 v[156:159], v16 offset:8192
    ds_read_b128 v[160:163], v16 offset:16384
    s_waitcnt lgkmcnt(10)
    v_mfma_f32_32x32x16_bf16 v[32:47], v[164:167], v[128:131], v[32:47]
    s_add_u32 s60, s64, 98304
    buffer_load_dwordx4 a[204:207], v7, s[20:23], s60 offen
    v_mfma_f32_32x32x16_bf16 v[48:63], v[164:167], v[132:135], v[48:63]
    s_add_u32 s60, s64, 131072
    buffer_load_dwordx4 a[208:211], v7, s[20:23], s60 offen
    v_mfma_f32_32x32x16_bf16 v[64:79], v[164:167], v[136:139], v[64:79]
    s_add_u32 s60, s64, 163840
    buffer_load_dwordx4 a[212:215], v7, s[20:23], s60 offen
    ds_read_b64_tr_b16 v[164:165], v10 offset:6144
    ds_read_b64_tr_b16 v[166:167], v10 offset:6400
    ds_read_b128 v[128:131], v17 offset:0
    ds_read_b128 v[132:135], v17 offset:8192
    ds_read_b128 v[136:139], v17 offset:16384
    s_waitcnt lgkmcnt(10)
    v_mfma_f32_32x32x16_bf16 v[32:47], v[168:171], v[140:143], v[32:47]
    s_add_u32 s60, s64, 196608
    buffer_load_dwordx4 a[216:219], v7, s[20:23], s60 offen
    v_mfma_f32_32x32x16_bf16 v[48:63], v[168:171], v[144:147], v[48:63]
    s_add_u32 s60, s64, 229376
    buffer_load_dwordx4 a[220:223], v7, s[20:23], s60 offen
    v_mfma_f32_32x32x16_bf16 v[64:79], v[168:171], v[148:151], v[64:79]
    s_add_u32 s63, s7, 3
    s_mov_b32 s63, 3
    s_lshl_b32 s64, s63, 20
    s_add_u32 s64, s64, s61
    s_lshl_b32 s63, s63, 8
    s_add_u32 s63, s63, s48
    s_add_u32 m0, s59, 73728
    s_add_u32 s60, s63, 0
    buffer_load_dwordx4 v121, s[8:11], s60 offen lds
    s_waitcnt vmcnt(15)
    ds_write_b128 v9, a[160:163] offset:8192
    ds_write_b128 v9, a[164:167] offset:8448
    ds_read_b64_tr_b16 v[168:169], v10 offset:7168
    ds_read_b64_tr_b16 v[170:171], v10 offset:7424
    ds_read_b128 v[140:143], v18 offset:0
    ds_read_b128 v[144:147], v18 offset:8192
    ds_read_b128 v[148:151], v18 offset:16384
    s_waitcnt lgkmcnt(12)
    v_mfma_f32_32x32x16_bf16 v[32:47], v[172:175], v[152:155], v[32:47]
    s_add_u32 m0, s59, 77824
    s_add_u32 s60, s63, 16384
    buffer_load_dwordx4 v121, s[8:11], s60 offen lds
    v_mfma_f32_32x32x16_bf16 v[48:63], v[172:175], v[156:159], v[48:63]
    s_add_u32 m0, s59, 81920
    s_add_u32 s60, s63, 32768
    buffer_load_dwordx4 v121, s[8:11], s60 offen lds
    v_mfma_f32_32x32x16_bf16 v[64:79], v[172:175], v[160:163], v[64:79]
    s_add_u32 m0, s59, 86016
    s_add_u32 s60, s63, 49152
    buffer_load_dwordx4 v121, s[8:11], s60 offen lds
    ds_write_b128 v9, a[168:171] offset:8704
    ds_write_b128 v9, a[172:175] offset:8960
    s_waitcnt lgkmcnt(7)
    v_mfma_f32_32x32x16_bf16 v[32:47], v[164:167], v[128:131], v[32:47]
    s_add_u32 m0, s59, 90112
    s_add_u32 s60, s63, 65536
    buffer_load_dwordx4 v121, s[8:11], s60 offen lds
    v_mfma_f32_32x32x16_bf16 v[48:63], v[164:167], v[132:135], v[48:63]
    s_add_u32 m0, s59, 94208
    s_add_u32 s60, s63, 81920
    buffer_load_dwordx4 v121, s[8:11], s60 offen lds
    v_mfma_f32_32x32x16_bf16 v[64:79], v[164:167], v[136:139], v[64:79]
    s_add_u32 s60, s64, 0
    buffer_load_dwordx4 a[224:227], v7, s[20:23], s60 offen
    ds_write_b128 v9, a[176:179] offset:9216
    ds_write_b128 v9, a[180:183] offset:9472
    s_waitcnt lgkmcnt(0)
    v_mfma_f32_32x32x16_bf16 v[32:47], v[168:171], v[140:143], v[32:47]
    s_add_u32 s60, s64, 32768
    buffer_load_dwordx4 a[228:231], v7, s[20:23], s60 offen
    v_mfma_f32_32x32x16_bf16 v[48:63], v[168:171], v[144:147], v[48:63]
    s_add_u32 s60, s64, 65536
    buffer_load_dwordx4 a[232:235], v7, s[20:23], s60 offen
    v_mfma_f32_32x32x16_bf16 v[64:79], v[168:171], v[148:151], v[64:79]
    s_add_u32 s60, s64, 98304
    buffer_load_dwordx4 a[236:239], v7, s[20:23], s60 offen
    s_add_u32 s60, s64, 131072
    buffer_load_dwordx4 a[240:243], v7, s[20:23], s60 offen
    s_add_u32 s60, s64, 163840
    buffer_load_dwordx4 a[244:247], v7, s[20:23], s60 offen
    s_add_u32 s60, s64, 196608
    buffer_load_dwordx4 a[248:251], v7, s[20:23], s60 offen
    s_add_u32 s60, s64, 229376
    buffer_load_dwordx4 a[252:255], v7, s[20:23], s60 offen
    s_lshr_b32 s43, s2, 3
    s_lshl_b32 s43, s43, 2
    s_add_u32 s43, s43, s40
    s_lshl_b32 s43, s43, 15
    s_and_b32 s44, s2, 7
    s_lshl_b32 s44, s44, 7
    s_add_u32 s43, s43, s44
    buffer_load_dwordx4 v[236:239], v29, s[24:27], s43 offen
    s_add_u32 s43, s43, 8192
    buffer_load_dwordx4 v[240:243], v29, s[24:27], s43 offen
    s_add_u32 s43, s43, 8192
    buffer_load_dwordx4 v[244:247], v29, s[24:27], s43 offen
    s_add_u32 s43, s43, 8192
    buffer_load_dwordx4 v[248:251], v29, s[24:27], s43 offen
    s_add_u32 s43, s43, 8192
    ds_write_b128 v9, a[184:187] offset:9728
    ds_write_b128 v9, a[188:191] offset:9984
    s_waitcnt lgkmcnt(0)
    s_barrier
    ds_read_b64_tr_b16 v[164:165], v10 offset:8192
    ds_read_b64_tr_b16 v[166:167], v10 offset:8448
    ds_read_b128 v[128:131], v11 offset:24576
    ds_read_b128 v[132:135], v11 offset:32768
    ds_read_b128 v[136:139], v11 offset:40960
    ds_read_b64_tr_b16 v[168:169], v10 offset:9216
    ds_read_b64_tr_b16 v[170:171], v10 offset:9472
    ds_read_b128 v[140:143], v12 offset:24576
    ds_read_b128 v[144:147], v12 offset:32768
    ds_read_b128 v[148:151], v12 offset:40960
    ds_read_b64_tr_b16 v[172:173], v10 offset:10240
    ds_read_b64_tr_b16 v[174:175], v10 offset:10496
    ds_read_b128 v[152:155], v13 offset:24576
    ds_read_b128 v[156:159], v13 offset:32768
    ds_read_b128 v[160:163], v13 offset:40960
    s_waitcnt lgkmcnt(10)
    v_mfma_f32_32x32x16_bf16 v[32:47], v[164:167], v[128:131], v[32:47]
    s_add_u32 s55, s47, 0
    buffer_load_dwordx4 a[0:3], v2, s[12:15], s55 offen offset:0 nt
    v_mfma_f32_32x32x16_bf16 v[48:63], v[164:167], v[132:135], v[48:63]
    v_mfma_f32_32x32x16_bf16 v[64:79], v[164:167], v[136:139], v[64:79]
    buffer_load_dwordx4 a[4:7], v2, s[12:15], s55 offen offset:64 nt
    ds_read_b64_tr_b16 v[164:165], v10 offset:11264
    ds_read_b64_tr_b16 v[166:167], v10 offset:11520
    ds_read_b128 v[128:131], v14 offset:24576
    ds_read_b128 v[132:135], v14 offset:32768
    ds_read_b128 v[136:139], v14 offset:40960
    s_waitcnt lgkmcnt(10)
    v_mfma_f32_32x32x16_bf16 v[32:47], v[168:171], v[140:143], v[32:47]
    buffer_load_dwordx4 a[8:11], v2, s[12:15], s55 offen offset:128 nt
    v_mfma_f32_32x32x16_bf16 v[48:63], v[168:171], v[144:147], v[48:63]
    v_mfma_f32_32x32x16_bf16 v[64:79], v[168:171], v[148:151], v[64:79]
    buffer_load_dwordx4 a[12:15], v2, s[12:15], s55 offen offset:192 nt
    ds_read_b64_tr_b16 v[168:169], v10 offset:12288
    ds_read_b64_tr_b16 v[170:171], v10 offset:12544
    ds_read_b128 v[140:143], v15 offset:24576
    ds_read_b128 v[144:147], v15 offset:32768
    ds_read_b128 v[148:151], v15 offset:40960
    s_waitcnt lgkmcnt(10)
    v_mfma_f32_32x32x16_bf16 v[32:47], v[172:175], v[152:155], v[32:47]
    s_add_u32 s55, s47, 4096
    buffer_load_dwordx4 a[16:19], v2, s[12:15], s55 offen offset:0 nt
    v_mfma_f32_32x32x16_bf16 v[48:63], v[172:175], v[156:159], v[48:63]
    v_mfma_f32_32x32x16_bf16 v[64:79], v[172:175], v[160:163], v[64:79]
    buffer_load_dwordx4 a[20:23], v2, s[12:15], s55 offen offset:64 nt
    ds_read_b64_tr_b16 v[172:173], v10 offset:13312
    ds_read_b64_tr_b16 v[174:175], v10 offset:13568
    ds_read_b128 v[152:155], v16 offset:24576
    ds_read_b128 v[156:159], v16 offset:32768
    ds_read_b128 v[160:163], v16 offset:40960
    s_waitcnt lgkmcnt(10)
    v_mfma_f32_32x32x16_bf16 v[32:47], v[164:167], v[128:131], v[32:47]
    buffer_load_dwordx4 a[24:27], v2, s[12:15], s55 offen offset:128 nt
    v_mfma_f32_32x32x16_bf16 v[48:63], v[164:167], v[132:135], v[48:63]
    v_mfma_f32_32x32x16_bf16 v[64:79], v[164:167], v[136:139], v[64:79]
    buffer_load_dwordx4 a[28:31], v2, s[12:15], s55 offen offset:192 nt
    ds_read_b64_tr_b16 v[164:165], v10 offset:14336
    ds_read_b64_tr_b16 v[166:167], v10 offset:14592
    ds_read_b128 v[128:131], v17 offset:24576
    ds_read_b128 v[132:135], v17 offset:32768
    ds_read_b128 v[136:139], v17 offset:40960
    s_waitcnt lgkmcnt(10)
    v_mfma_f32_32x32x16_bf16 v[32:47], v[168:171], v[140:143], v[32:47]
    s_add_u32 s55, s47, 8192
    buffer_load_dwordx4 a[32:35], v2, s[12:15], s55 offen offset:0 nt
    v_mfma_f32_32x32x16_bf16 v[48:63], v[168:171], v[144:147], v[48:63]
    v_mfma_f32_32x32x16_bf16 v[64:79], v[168:171], v[148:151], v[64:79]
    buffer_load_dwordx4 a[36:39], v2, s[12:15], s55 offen offset:64 nt
    s_waitcnt vmcnt(28)
    ds_write_b128 v9, a[192:195] offset:0
    ds_write_b128 v9, a[196:199] offset:256
    ds_read_b64_tr_b16 v[168:169], v10 offset:15360
    ds_read_b64_tr_b16 v[170:171], v10 offset:15616
    ds_read_b128 v[140:143], v18 offset:24576
    ds_read_b128 v[144:147], v18 offset:32768
    ds_read_b128 v[148:151], v18 offset:40960
    s_waitcnt lgkmcnt(12)
    v_mfma_f32_32x32x16_bf16 v[32:47], v[172:175], v[152:155], v[32:47]
    buffer_load_dwordx4 a[40:43], v2, s[12:15], s55 offen offset:128 nt
    v_mfma_f32_32x32x16_bf16 v[48:63], v[172:175], v[156:159], v[48:63]
    v_mfma_f32_32x32x16_bf16 v[64:79], v[172:175], v[160:163], v[64:79]
    buffer_load_dwordx4 a[44:47], v2, s[12:15], s55 offen offset:192 nt
    ds_write_b128 v9, a[200:203] offset:512
    ds_write_b128 v9, a[204:207] offset:768
    s_waitcnt lgkmcnt(7)
    v_mfma_f32_32x32x16_bf16 v[32:47], v[164:167], v[128:131], v[32:47]
    v_mfma_f32_32x32x16_bf16 v[48:63], v[164:167], v[132:135], v[48:63]
    v_mfma_f32_32x32x16_bf16 v[64:79], v[164:167], v[136:139], v[64:79]
    ds_write_b128 v9, a[208:211] offset:1024
    ds_write_b128 v9, a[212:215] offset:1280
    s_waitcnt lgkmcnt(0)
    v_mfma_f32_32x32x16_bf16 v[32:47], v[168:171], v[140:143], v[32:47]
    v_mfma_f32_32x32x16_bf16 v[48:63], v[168:171], v[144:147], v[48:63]
    v_mfma_f32_32x32x16_bf16 v[64:79], v[168:171], v[148:151], v[64:79]
    ds_write_b128 v9, a[216:219] offset:1536
    ds_write_b128 v9, a[220:223] offset:1792
    s_waitcnt lgkmcnt(0)
    s_barrier
    ds_read_b64_tr_b16 v[164:165], v10 offset:0
    ds_read_b64_tr_b16 v[166:167], v10 offset:256
    ds_read_b128 v[128:131], v112 offset:0
    ds_read_b128 v[132:135], v112 offset:8192
    ds_read_b128 v[136:139], v112 offset:16384
    ds_read_b64_tr_b16 v[168:169], v10 offset:1024
    ds_read_b64_tr_b16 v[170:171], v10 offset:1280
    ds_read_b128 v[140:143], v113 offset:0
    ds_read_b128 v[144:147], v113 offset:8192
    ds_read_b128 v[148:151], v113 offset:16384
    ds_read_b64_tr_b16 v[172:173], v10 offset:2048
    ds_read_b64_tr_b16 v[174:175], v10 offset:2304
    ds_read_b128 v[152:155], v114 offset:0
    ds_read_b128 v[156:159], v114 offset:8192
    ds_read_b128 v[160:163], v114 offset:16384
    s_waitcnt lgkmcnt(10)
    v_mfma_f32_32x32x16_bf16 v[32:47], v[164:167], v[128:131], v[32:47]
    v_mfma_f32_32x32x16_bf16 v[48:63], v[164:167], v[132:135], v[48:63]
    v_mfma_f32_32x32x16_bf16 v[64:79], v[164:167], v[136:139], v[64:79]
    ds_read_b64_tr_b16 v[164:165], v10 offset:3072
    ds_read_b64_tr_b16 v[166:167], v10 offset:3328
    ds_read_b128 v[128:131], v115 offset:0
    ds_read_b128 v[132:135], v115 offset:8192
    ds_read_b128 v[136:139], v115 offset:16384
    s_waitcnt lgkmcnt(10)
    v_mfma_f32_32x32x16_bf16 v[32:47], v[168:171], v[140:143], v[32:47]
    v_mfma_f32_32x32x16_bf16 v[48:63], v[168:171], v[144:147], v[48:63]
    v_mfma_f32_32x32x16_bf16 v[64:79], v[168:171], v[148:151], v[64:79]
    ds_read_b64_tr_b16 v[168:169], v10 offset:4096
    ds_read_b64_tr_b16 v[170:171], v10 offset:4352
    ds_read_b128 v[140:143], v116 offset:0
    ds_read_b128 v[144:147], v116 offset:8192
    ds_read_b128 v[148:151], v116 offset:16384
    s_waitcnt lgkmcnt(10)
    v_mfma_f32_32x32x16_bf16 v[32:47], v[172:175], v[152:155], v[32:47]
    v_mfma_f32_32x32x16_bf16 v[48:63], v[172:175], v[156:159], v[48:63]
    v_mfma_f32_32x32x16_bf16 v[64:79], v[172:175], v[160:163], v[64:79]
    ds_read_b64_tr_b16 v[172:173], v10 offset:5120
    ds_read_b64_tr_b16 v[174:175], v10 offset:5376
    ds_read_b128 v[152:155], v117 offset:0
    ds_read_b128 v[156:159], v117 offset:8192
    ds_read_b128 v[160:163], v117 offset:16384
    s_waitcnt lgkmcnt(10)
    v_mfma_f32_32x32x16_bf16 v[32:47], v[164:167], v[128:131], v[32:47]
    v_mfma_f32_32x32x16_bf16 v[48:63], v[164:167], v[132:135], v[48:63]
    v_mfma_f32_32x32x16_bf16 v[64:79], v[164:167], v[136:139], v[64:79]
    ds_read_b64_tr_b16 v[164:165], v10 offset:6144
    ds_read_b64_tr_b16 v[166:167], v10 offset:6400
    ds_read_b128 v[128:131], v118 offset:0
    ds_read_b128 v[132:135], v118 offset:8192
    ds_read_b128 v[136:139], v118 offset:16384
    s_waitcnt lgkmcnt(10)
    v_mfma_f32_32x32x16_bf16 v[32:47], v[168:171], v[140:143], v[32:47]
    v_mfma_f32_32x32x16_bf16 v[48:63], v[168:171], v[144:147], v[48:63]
    v_mfma_f32_32x32x16_bf16 v[64:79], v[168:171], v[148:151], v[64:79]
    s_waitcnt vmcnt(16)
    ds_write_b128 v9, a[224:227] offset:8192
    ds_write_b128 v9, a[228:231] offset:8448
    ds_read_b64_tr_b16 v[168:169], v10 offset:7168
    ds_read_b64_tr_b16 v[170:171], v10 offset:7424
    ds_read_b128 v[140:143], v119 offset:0
    ds_read_b128 v[144:147], v119 offset:8192
    ds_read_b128 v[148:151], v119 offset:16384
    s_waitcnt lgkmcnt(12)
    v_mfma_f32_32x32x16_bf16 v[32:47], v[172:175], v[152:155], v[32:47]
    v_mfma_f32_32x32x16_bf16 v[48:63], v[172:175], v[156:159], v[48:63]
    v_mfma_f32_32x32x16_bf16 v[64:79], v[172:175], v[160:163], v[64:79]
    ds_write_b128 v9, a[232:235] offset:8704
    ds_write_b128 v9, a[236:239] offset:8960
    s_waitcnt lgkmcnt(7)
    v_mfma_f32_32x32x16_bf16 v[32:47], v[164:167], v[128:131], v[32:47]
    v_mfma_f32_32x32x16_bf16 v[48:63], v[164:167], v[132:135], v[48:63]
    v_mfma_f32_32x32x16_bf16 v[64:79], v[164:167], v[136:139], v[64:79]
    ds_write_b128 v9, a[240:243] offset:9216
    ds_write_b128 v9, a[244:247] offset:9472
    s_waitcnt lgkmcnt(0)
    v_mfma_f32_32x32x16_bf16 v[32:47], v[168:171], v[140:143], v[32:47]
    v_mfma_f32_32x32x16_bf16 v[48:63], v[168:171], v[144:147], v[48:63]
    v_mfma_f32_32x32x16_bf16 v[64:79], v[168:171], v[148:151], v[64:79]
    ds_write_b128 v9, a[248:251] offset:9728
    ds_write_b128 v9, a[252:255] offset:9984
    s_waitcnt lgkmcnt(0)
    s_barrier
    ds_read_b64_tr_b16 v[164:165], v10 offset:8192
    ds_read_b64_tr_b16 v[166:167], v10 offset:8448
    ds_read_b128 v[128:131], v112 offset:24576
    ds_read_b128 v[132:135], v112 offset:32768
    ds_read_b128 v[136:139], v112 offset:40960
    ds_read_b64_tr_b16 v[168:169], v10 offset:9216
    ds_read_b64_tr_b16 v[170:171], v10 offset:9472
    ds_read_b128 v[140:143], v113 offset:24576
    ds_read_b128 v[144:147], v113 offset:32768
    ds_read_b128 v[148:151], v113 offset:40960
    ds_read_b64_tr_b16 v[172:173], v10 offset:10240
    ds_read_b64_tr_b16 v[174:175], v10 offset:10496
    ds_read_b128 v[152:155], v114 offset:24576
    ds_read_b128 v[156:159], v114 offset:32768
    ds_read_b128 v[160:163], v114 offset:40960
    s_waitcnt lgkmcnt(10)
    v_mfma_f32_32x32x16_bf16 v[32:47], v[164:167], v[128:131], v[32:47]
    s_add_u32 s55, s47, 12288
    buffer_load_dwordx4 a[48:51], v2, s[12:15], s55 offen offset:0 nt
    v_mfma_f32_32x32x16_bf16 v[48:63], v[164:167], v[132:135], v[48:63]
    v_mfma_f32_32x32x16_bf16 v[64:79], v[164:167], v[136:139], v[64:79]
    buffer_load_dwordx4 a[52:55], v2, s[12:15], s55 offen offset:64 nt
    ds_read_b64_tr_b16 v[164:165], v10 offset:11264
    ds_read_b64_tr_b16 v[166:167], v10 offset:11520
    ds_read_b128 v[128:131], v115 offset:24576
    ds_read_b128 v[132:135], v115 offset:32768
    ds_read_b128 v[136:139], v115 offset:40960
    s_waitcnt lgkmcnt(10)
    v_mfma_f32_32x32x16_bf16 v[32:47], v[168:171], v[140:143], v[32:47]
    buffer_load_dwordx4 a[56:59], v2, s[12:15], s55 offen offset:128 nt
    v_mfma_f32_32x32x16_bf16 v[48:63], v[168:171], v[144:147], v[48:63]
    v_mfma_f32_32x32x16_bf16 v[64:79], v[168:171], v[148:151], v[64:79]
    buffer_load_dwordx4 a[60:63], v2, s[12:15], s55 offen offset:192 nt
    ds_read_b64_tr_b16 v[168:169], v10 offset:12288
    ds_read_b64_tr_b16 v[170:171], v10 offset:12544
    ds_read_b128 v[140:143], v116 offset:24576
    ds_read_b128 v[144:147], v116 offset:32768
    ds_read_b128 v[148:151], v116 offset:40960
    s_waitcnt lgkmcnt(10)
    v_mfma_f32_32x32x16_bf16 v[32:47], v[172:175], v[152:155], v[32:47]
    v_mfma_f32_32x32x16_bf16 v[48:63], v[172:175], v[156:159], v[48:63]
    v_mfma_f32_32x32x16_bf16 v[64:79], v[172:175], v[160:163], v[64:79]
    ds_read_b64_tr_b16 v[172:173], v10 offset:13312
    ds_read_b64_tr_b16 v[174:175], v10 offset:13568
    ds_read_b128 v[152:155], v117 offset:24576
    ds_read_b128 v[156:159], v117 offset:32768
    ds_read_b128 v[160:163], v117 offset:40960
    s_waitcnt lgkmcnt(10)
    v_mfma_f32_32x32x16_bf16 v[32:47], v[164:167], v[128:131], v[32:47]
    v_mfma_f32_32x32x16_bf16 v[48:63], v[164:167], v[132:135], v[48:63]
    v_mfma_f32_32x32x16_bf16 v[64:79], v[164:167], v[136:139], v[64:79]
    ds_read_b64_tr_b16 v[164:165], v10 offset:14336
    ds_read_b64_tr_b16 v[166:167], v10 offset:14592
    ds_read_b128 v[128:131], v118 offset:24576
    ds_read_b128 v[132:135], v118 offset:32768
    ds_read_b128 v[136:139], v118 offset:40960
    s_waitcnt lgkmcnt(10)
    v_mfma_f32_32x32x16_bf16 v[32:47], v[168:171], v[140:143], v[32:47]
    v_mfma_f32_32x32x16_bf16 v[48:63], v[168:171], v[144:147], v[48:63]
    v_mfma_f32_32x32x16_bf16 v[64:79], v[168:171], v[148:151], v[64:79]
    ds_read_b64_tr_b16 v[168:169], v10 offset:15360
    ds_read_b64_tr_b16 v[170:171], v10 offset:15616
    ds_read_b128 v[140:143], v119 offset:24576
    ds_read_b128 v[144:147], v119 offset:32768
    ds_read_b128 v[148:151], v119 offset:40960
    s_waitcnt lgkmcnt(10)
    v_mfma_f32_32x32x16_bf16 v[32:47], v[172:175], v[152:155], v[32:47]
    v_mfma_f32_32x32x16_bf16 v[48:63], v[172:175], v[156:159], v[48:63]
    v_mfma_f32_32x32x16_bf16 v[64:79], v[172:175], v[160:163], v[64:79]
    s_waitcnt lgkmcnt(5)
    v_mfma_f32_32x32x16_bf16 v[32:47], v[164:167], v[128:131], v[32:47]
    v_mfma_f32_32x32x16_bf16 v[48:63], v[164:167], v[132:135], v[48:63]
    v_mfma_f32_32x32x16_bf16 v[64:79], v[164:167], v[136:139], v[64:79]
    s_waitcnt lgkmcnt(0)
    v_mfma_f32_32x32x16_bf16 v[32:47], v[168:171], v[140:143], v[32:47]
    v_mfma_f32_32x32x16_bf16 v[48:63], v[168:171], v[144:147], v[48:63]
    v_mfma_f32_32x32x16_bf16 v[64:79], v[168:171], v[148:151], v[64:79]
    s_barrier
    s_nop 11
    v_cvt_pk_bf16_f32 v128, v32, v33
    v_cvt_pk_bf16_f32 v129, v34, v35
    v_cvt_pk_bf16_f32 v130, v36, v37
    v_cvt_pk_bf16_f32 v131, v38, v39
    ds_write_b128 v19, v[128:131] offset:0
    v_cvt_pk_bf16_f32 v132, v40, v41
    v_cvt_pk_bf16_f32 v133, v42, v43
    v_cvt_pk_bf16_f32 v134, v44, v45
    v_cvt_pk_bf16_f32 v135, v46, v47
    ds_write_b128 v19, v[132:135] offset:512
    v_cvt_pk_bf16_f32 v136, v48, v49
    v_cvt_pk_bf16_f32 v137, v50, v51
    v_cvt_pk_bf16_f32 v138, v52, v53
    v_cvt_pk_bf16_f32 v139, v54, v55
    ds_write_b128 v19, v[136:139] offset:8192
    v_cvt_pk_bf16_f32 v140, v56, v57
    v_cvt_pk_bf16_f32 v141, v58, v59
    v_cvt_pk_bf16_f32 v142, v60, v61
    v_cvt_pk_bf16_f32 v143, v62, v63
    ds_write_b128 v19, v[140:143] offset:8704
    v_cvt_pk_bf16_f32 v144, v64, v65
    v_cvt_pk_bf16_f32 v145, v66, v67
    v_cvt_pk_bf16_f32 v146, v68, v69
    v_cvt_pk_bf16_f32 v147, v70, v71
    ds_write_b128 v19, v[144:147] offset:16384
    v_cvt_pk_bf16_f32 v148, v72, v73
    v_cvt_pk_bf16_f32 v149, v74, v75
    v_cvt_pk_bf16_f32 v150, v76, v77
    v_cvt_pk_bf16_f32 v151, v78, v79
    ds_write_b128 v19, v[148:151] offset:16896
    s_add_u32 s55, s47, 16384
    buffer_load_dwordx4 a[64:67], v2, s[12:15], s55 offen offset:0 nt
    buffer_load_dwordx4 a[68:71], v2, s[12:15], s55 offen offset:64 nt
    buffer_load_dwordx4 a[72:75], v2, s[12:15], s55 offen offset:128 nt
    buffer_load_dwordx4 a[76:79], v2, s[12:15], s55 offen offset:192 nt
    s_waitcnt lgkmcnt(0)
    s_barrier
    v_add_u32 v30, 131072, v8
    ds_read_b128 a[128:131], v30 offset:0
    ds_read_b128 a[132:135], v30 offset:1024
    ds_read_b128 a[136:139], v30 offset:2048
    ds_read_b128 a[140:143], v30 offset:3072
    ds_read_b128 a[144:147], v30 offset:4096
    ds_read_b128 a[148:151], v30 offset:5120
    ds_read_b128 a[152:155], v30 offset:6144
    ds_read_b128 a[156:159], v30 offset:7168
    ds_read_b128 a[160:163], v30 offset:8192
    ds_read_b128 a[164:167], v30 offset:9216
    ds_read_b128 a[168:171], v30 offset:10240
    ds_read_b128 a[172:175], v30 offset:11264
    ds_read_b128 a[176:179], v30 offset:12288
    ds_read_b128 a[180:183], v30 offset:13312
    ds_read_b128 a[184:187], v30 offset:14336
    ds_read_b128 a[188:191], v30 offset:15360
    ds_read_b128 a[192:195], v30 offset:16384
    ds_read_b128 a[196:199], v30 offset:17408
    ds_read_b128 a[200:203], v30 offset:18432
    ds_read_b128 a[204:207], v30 offset:19456
    ds_read_b128 a[208:211], v30 offset:20480
    ds_read_b128 a[212:215], v30 offset:21504
    ds_read_b128 a[216:219], v30 offset:22528
    ds_read_b128 a[220:223], v30 offset:23552
    s_waitcnt vmcnt(16) lgkmcnt(0)
    v_mov_b32 v19, 0
    buffer_load_dword v7, v19, s[36:39], 0 offen sc1
    v_lshrrev_b32 v30, 4, v1
    v_lshlrev_b32 v30, 1, v30
    v_xor_b32 v30, v30, v1
    v_lshl_add_u32 v30, v30, 4, s57
    ds_write_b128 v30, v[236:239] offset:16384
    ds_write_b128 v30, v[240:243] offset:17408
    ds_write_b128 v30, v[244:247] offset:18432
    ds_write_b128 v30, v[248:251] offset:19456
    v_mfma_f32_16x16x32_bf16 v[32:35], a[0:3], a[128:131], 0
    v_mfma_f32_16x16x32_bf16 v[36:39], a[0:3], a[144:147], 0
    v_mfma_f32_16x16x32_bf16 v[40:43], a[0:3], a[160:163], 0
    s_add_u32 s55, s47, 20480
    buffer_load_dwordx4 a[80:83], v2, s[12:15], s55 offen offset:0 nt
    v_mfma_f32_16x16x32_bf16 v[44:47], a[0:3], a[176:179], 0
    v_mfma_f32_16x16x32_bf16 v[48:51], a[0:3], a[192:195], 0
    v_mfma_f32_16x16x32_bf16 v[52:55], a[0:3], a[208:211], 0
    v_mfma_f32_16x16x32_bf16 v[32:35], a[4:7], a[132:135], v[32:35]
    v_mfma_f32_16x16x32_bf16 v[36:39], a[4:7], a[148:151], v[36:39]
    v_mfma_f32_16x16x32_bf16 v[40:43], a[4:7], a[164:167], v[40:43]
    buffer_load_dwordx4 a[84:87], v2, s[12:15], s55 offen offset:64 nt
    v_mfma_f32_16x16x32_bf16 v[44:47], a[4:7], a[180:183], v[44:47]
    v_mfma_f32_16x16x32_bf16 v[48:51], a[4:7], a[196:199], v[48:51]
    v_mfma_f32_16x16x32_bf16 v[52:55], a[4:7], a[212:215], v[52:55]
    v_mfma_f32_16x16x32_bf16 v[32:35], a[8:11], a[136:139], v[32:35]
    v_mfma_f32_16x16x32_bf16 v[36:39], a[8:11], a[152:155], v[36:39]
    v_mfma_f32_16x16x32_bf16 v[40:43], a[8:11], a[168:171], v[40:43]
    buffer_load_dwordx4 a[88:91], v2, s[12:15], s55 offen offset:128 nt
    v_mfma_f32_16x16x32_bf16 v[44:47], a[8:11], a[184:187], v[44:47]
    v_mfma_f32_16x16x32_bf16 v[48:51], a[8:11], a[200:203], v[48:51]
    v_mfma_f32_16x16x32_bf16 v[52:55], a[8:11], a[216:219], v[52:55]
    v_mfma_f32_16x16x32_bf16 v[32:35], a[12:15], a[140:143], v[32:35]
    v_mfma_f32_16x16x32_bf16 v[36:39], a[12:15], a[156:159], v[36:39]
    v_mfma_f32_16x16x32_bf16 v[40:43], a[12:15], a[172:175], v[40:43]
    buffer_load_dwordx4 a[92:95], v2, s[12:15], s55 offen offset:192 nt
    v_mfma_f32_16x16x32_bf16 v[44:47], a[12:15], a[188:191], v[44:47]
    v_mfma_f32_16x16x32_bf16 v[48:51], a[12:15], a[204:207], v[48:51]
    v_mfma_f32_16x16x32_bf16 v[52:55], a[12:15], a[220:223], v[52:55]
    s_waitcnt vmcnt(17)
    s_waitcnt lgkmcnt(0)
    ds_read_b64_tr_b16 v[236:237], v21 offset:16384
    ds_read_b64_tr_b16 v[238:239], v21 offset:18432
    ds_read_b64_tr_b16 v[240:241], v22 offset:16384
    ds_read_b64_tr_b16 v[242:243], v22 offset:18432
    ds_read_b64_tr_b16 v[244:245], v23 offset:16384
    ds_read_b64_tr_b16 v[246:247], v23 offset:18432
    ds_read_b64_tr_b16 v[248:249], v24 offset:16384
    ds_read_b64_tr_b16 v[250:251], v24 offset:18432
    v_mfma_f32_16x16x32_bf16 v[56:59], a[16:19], a[128:131], 0
    v_mfma_f32_16x16x32_bf16 v[60:63], a[16:19], a[144:147], 0
    v_mfma_f32_16x16x32_bf16 v[64:67], a[16:19], a[160:163], 0
    s_add_u32 s55, s47, 24576
    buffer_load_dwordx4 a[96:99], v2, s[12:15], s55 offen offset:0 nt
    v_mfma_f32_16x16x32_bf16 v[68:71], a[16:19], a[176:179], 0
    v_mfma_f32_16x16x32_bf16 v[72:75], a[16:19], a[192:195], 0
    v_mfma_f32_16x16x32_bf16 v[76:79], a[16:19], a[208:211], 0
    v_mfma_f32_16x16x32_bf16 v[56:59], a[20:23], a[132:135], v[56:59]
    v_max_f32 v224, v32, v33
    v_mfma_f32_16x16x32_bf16 v[60:63], a[20:23], a[148:151], v[60:63]
    v_max_f32 v225, v36, v37
    v_mfma_f32_16x16x32_bf16 v[64:67], a[20:23], a[164:167], v[64:67]
    buffer_load_dwordx4 a[100:103], v2, s[12:15], s55 offen offset:64 nt
    v_max_f32 v226, v40, v41
    v_mfma_f32_16x16x32_bf16 v[68:71], a[20:23], a[180:183], v[68:71]
    v_max_f32 v227, v44, v45
    v_mfma_f32_16x16x32_bf16 v[72:75], a[20:23], a[196:199], v[72:75]
    v_max_f32 v228, v48, v49
    v_mfma_f32_16x16x32_bf16 v[76:79], a[20:23], a[212:215], v[76:79]
    v_max_f32 v229, v52, v53
    v_mfma_f32_16x16x32_bf16 v[56:59], a[24:27], a[136:139], v[56:59]
    v_max3_f32 v224, v224, v34, v35
    v_mfma_f32_16x16x32_bf16 v[60:63], a[24:27], a[152:155], v[60:63]
    v_max3_f32 v225, v225, v38, v39
    v_mfma_f32_16x16x32_bf16 v[64:67], a[24:27], a[168:171], v[64:67]
    buffer_load_dwordx4 a[104:107], v2, s[12:15], s55 offen offset:128 nt
    v_max3_f32 v226, v226, v42, v43
    v_mfma_f32_16x16x32_bf16 v[68:71], a[24:27], a[184:187], v[68:71]
    v_max3_f32 v227, v227, v46, v47
    v_mfma_f32_16x16x32_bf16 v[72:75], a[24:27], a[200:203], v[72:75]
    v_max3_f32 v228, v228, v50, v51
    v_mfma_f32_16x16x32_bf16 v[76:79], a[24:27], a[216:219], v[76:79]
    v_max3_f32 v229, v229, v54, v55
    v_mfma_f32_16x16x32_bf16 v[56:59], a[28:31], a[140:143], v[56:59]
    v_mfma_f32_16x16x32_bf16 v[60:63], a[28:31], a[156:159], v[60:63]
    v_mfma_f32_16x16x32_bf16 v[64:67], a[28:31], a[172:175], v[64:67]
    buffer_load_dwordx4 a[108:111], v2, s[12:15], s55 offen offset:192 nt
    v_mfma_f32_16x16x32_bf16 v[68:71], a[28:31], a[188:191], v[68:71]
    v_mfma_f32_16x16x32_bf16 v[72:75], a[28:31], a[204:207], v[72:75]
    v_mfma_f32_16x16x32_bf16 v[76:79], a[28:31], a[220:223], v[76:79]
    s_waitcnt vmcnt(17)
    s_and_b32 s43, s2, 7
    s_lshl_b32 s43, s43, 7
    s_lshr_b32 s44, s2, 3
    s_lshl_b32 s44, s44, 2
    s_add_u32 s43, s43, s44
    s_add_u32 s43, s43, s40
    s_lshl_b32 s43, s43, 12
    s_add_u32 s43, s43, 12582912
    s_and_b32 s44, s40, 1
    s_lshl_b32 s44, s44, 11
    s_add_u32 s45, s43, s44
    s_xor_b32 s44, s44, 2048
    s_add_u32 s43, s43, s44
    s_waitcnt lgkmcnt(0)
    buffer_store_dwordx4 v[236:239], v8, s[32:35], s43 offen offset:0 sc1
    buffer_store_dwordx4 v[240:243], v8, s[32:35], s43 offen offset:1024 sc1
    buffer_store_dwordx4 v[244:247], v8, s[32:35], s45 offen offset:0 sc1
    buffer_store_dwordx4 v[248:251], v8, s[32:35], s45 offen offset:1024 sc1
    v_mfma_f32_16x16x32_bf16 v[80:83], a[32:35], a[128:131], 0
    v_mfma_f32_16x16x32_bf16 v[84:87], a[32:35], a[144:147], 0
    v_mfma_f32_16x16x32_bf16 v[88:91], a[32:35], a[160:163], 0
    s_add_u32 s55, s47, 28672
    buffer_load_dwordx4 a[112:115], v2, s[12:15], s55 offen offset:0 nt
    v_mfma_f32_16x16x32_bf16 v[92:95], a[32:35], a[176:179], 0
    v_mfma_f32_16x16x32_bf16 v[96:99], a[32:35], a[192:195], 0
    v_mfma_f32_16x16x32_bf16 v[100:103], a[32:35], a[208:211], 0
    v_mfma_f32_16x16x32_bf16 v[80:83], a[36:39], a[132:135], v[80:83]
    v_max3_f32 v224, v224, v56, v57
    v_mfma_f32_16x16x32_bf16 v[84:87], a[36:39], a[148:151], v[84:87]
    v_max3_f32 v225, v225, v60, v61
    v_mfma_f32_16x16x32_bf16 v[88:91], a[36:39], a[164:167], v[88:91]
    buffer_load_dwordx4 a[116:119], v2, s[12:15], s55 offen offset:64 nt
    v_max3_f32 v226, v226, v64, v65
    v_mfma_f32_16x16x32_bf16 v[92:95], a[36:39], a[180:183], v[92:95]
    v_max3_f32 v227, v227, v68, v69
    v_mfma_f32_16x16x32_bf16 v[96:99], a[36:39], a[196:199], v[96:99]
    v_max3_f32 v228, v228, v72, v73
    v_mfma_f32_16x16x32_bf16 v[100:103], a[36:39], a[212:215], v[100:103]
    v_max3_f32 v229, v229, v76, v77
    v_mfma_f32_16x16x32_bf16 v[80:83], a[40:43], a[136:139], v[80:83]
    v_max3_f32 v224, v224, v58, v59
    v_mfma_f32_16x16x32_bf16 v[84:87], a[40:43], a[152:155], v[84:87]
    v_max3_f32 v225, v225, v62, v63
    v_mfma_f32_16x16x32_bf16 v[88:91], a[40:43], a[168:171], v[88:91]
    buffer_load_dwordx4 a[120:123], v2, s[12:15], s55 offen offset:128 nt
    v_max3_f32 v226, v226, v66, v67
    v_mfma_f32_16x16x32_bf16 v[92:95], a[40:43], a[184:187], v[92:95]
    v_max3_f32 v227, v227, v70, v71
    v_mfma_f32_16x16x32_bf16 v[96:99], a[40:43], a[200:203], v[96:99]
    v_max3_f32 v228, v228, v74, v75
    v_mfma_f32_16x16x32_bf16 v[100:103], a[40:43], a[216:219], v[100:103]
    v_max3_f32 v229, v229, v78, v79
    v_mfma_f32_16x16x32_bf16 v[80:83], a[44:47], a[140:143], v[80:83]
    v_mfma_f32_16x16x32_bf16 v[84:87], a[44:47], a[156:159], v[84:87]
    v_mfma_f32_16x16x32_bf16 v[88:91], a[44:47], a[172:175], v[88:91]
    buffer_load_dwordx4 a[124:127], v2, s[12:15], s55 offen offset:192 nt
    v_mfma_f32_16x16x32_bf16 v[92:95], a[44:47], a[188:191], v[92:95]
    v_mfma_f32_16x16x32_bf16 v[96:99], a[44:47], a[204:207], v[96:99]
    v_mfma_f32_16x16x32_bf16 v[100:103], a[44:47], a[220:223], v[100:103]
    s_waitcnt vmcnt(21)
    v_mfma_f32_16x16x32_bf16 v[104:107], a[48:51], a[128:131], 0
    v_mfma_f32_16x16x32_bf16 v[108:111], a[48:51], a[144:147], 0
    v_mfma_f32_16x16x32_bf16 v[112:115], a[48:51], a[160:163], 0
    s_lshr_b32 s56, s40, 1
    s_xor_b32 s56, s56, 1
    s_lshl_b32 s56, s56, 7
    s_add_u32 s56, s56, s47
    s_add_u32 m0, s57, 0
    s_add_u32 s55, s56, 0
    buffer_load_dwordx4 v20, s[16:19], s55 offen nt lds
    v_mfma_f32_16x16x32_bf16 v[116:119], a[48:51], a[176:179], 0
    v_mfma_f32_16x16x32_bf16 v[120:123], a[48:51], a[192:195], 0
    v_mfma_f32_16x16x32_bf16 v[124:127], a[48:51], a[208:211], 0
    v_mfma_f32_16x16x32_bf16 v[104:107], a[52:55], a[132:135], v[104:107]
    v_max3_f32 v224, v224, v80, v81
    v_mfma_f32_16x16x32_bf16 v[108:111], a[52:55], a[148:151], v[108:111]
    v_max3_f32 v225, v225, v84, v85
    v_mfma_f32_16x16x32_bf16 v[112:115], a[52:55], a[164:167], v[112:115]
    v_max3_f32 v226, v226, v88, v89
    v_mfma_f32_16x16x32_bf16 v[116:119], a[52:55], a[180:183], v[116:119]
    v_max3_f32 v227, v227, v92, v93
    v_mfma_f32_16x16x32_bf16 v[120:123], a[52:55], a[196:199], v[120:123]
    v_max3_f32 v228, v228, v96, v97
    v_mfma_f32_16x16x32_bf16 v[124:127], a[52:55], a[212:215], v[124:127]
    v_max3_f32 v229, v229, v100, v101
    v_mfma_f32_16x16x32_bf16 v[104:107], a[56:59], a[136:139], v[104:107]
    v_max3_f32 v224, v224, v82, v83
    v_mfma_f32_16x16x32_bf16 v[108:111], a[56:59], a[152:155], v[108:111]
    v_max3_f32 v225, v225, v86, v87
    v_mfma_f32_16x16x32_bf16 v[112:115], a[56:59], a[168:171], v[112:115]
    v_max3_f32 v226, v226, v90, v91
    v_mfma_f32_16x16x32_bf16 v[116:119], a[56:59], a[184:187], v[116:119]
    v_max3_f32 v227, v227, v94, v95
    v_mfma_f32_16x16x32_bf16 v[120:123], a[56:59], a[200:203], v[120:123]
    v_max3_f32 v228, v228, v98, v99
    v_mfma_f32_16x16x32_bf16 v[124:127], a[56:59], a[216:219], v[124:127]
    v_max3_f32 v229, v229, v102, v103
    v_mfma_f32_16x16x32_bf16 v[104:107], a[60:63], a[140:143], v[104:107]
    v_mfma_f32_16x16x32_bf16 v[108:111], a[60:63], a[156:159], v[108:111]
    v_mfma_f32_16x16x32_bf16 v[112:115], a[60:63], a[172:175], v[112:115]
    v_mfma_f32_16x16x32_bf16 v[116:119], a[60:63], a[188:191], v[116:119]
    v_mfma_f32_16x16x32_bf16 v[120:123], a[60:63], a[204:207], v[120:123]
    v_mfma_f32_16x16x32_bf16 v[124:127], a[60:63], a[220:223], v[124:127]
    s_waitcnt vmcnt(18)
    v_mfma_f32_16x16x32_bf16 v[128:131], a[64:67], a[128:131], 0
    v_mfma_f32_16x16x32_bf16 v[132:135], a[64:67], a[144:147], 0
    v_mfma_f32_16x16x32_bf16 v[136:139], a[64:67], a[160:163], 0
    s_add_u32 m0, s57, 1024
    s_add_u32 s55, s56, 2048
    buffer_load_dwordx4 v20, s[16:19], s55 offen nt lds
    v_mfma_f32_16x16x32_bf16 v[140:143], a[64:67], a[176:179], 0
    v_mfma_f32_16x16x32_bf16 v[144:147], a[64:67], a[192:195], 0
    v_mfma_f32_16x16x32_bf16 v[148:151], a[64:67], a[208:211], 0
    v_mfma_f32_16x16x32_bf16 v[128:131], a[68:71], a[132:135], v[128:131]
    v_max3_f32 v224, v224, v104, v105
    v_mfma_f32_16x16x32_bf16 v[132:135], a[68:71], a[148:151], v[132:135]
    v_max3_f32 v225, v225, v108, v109
    v_mfma_f32_16x16x32_bf16 v[136:139], a[68:71], a[164:167], v[136:139]
    v_max3_f32 v226, v226, v112, v113
    v_mfma_f32_16x16x32_bf16 v[140:143], a[68:71], a[180:183], v[140:143]
    v_max3_f32 v227, v227, v116, v117
    v_mfma_f32_16x16x32_bf16 v[144:147], a[68:71], a[196:199], v[144:147]
    v_max3_f32 v228, v228, v120, v121
    v_mfma_f32_16x16x32_bf16 v[148:151], a[68:71], a[212:215], v[148:151]
    v_max3_f32 v229, v229, v124, v125
    v_mfma_f32_16x16x32_bf16 v[128:131], a[72:75], a[136:139], v[128:131]
    v_max3_f32 v224, v224, v106, v107
    v_mfma_f32_16x16x32_bf16 v[132:135], a[72:75], a[152:155], v[132:135]
    v_max3_f32 v225, v225, v110, v111
    v_mfma_f32_16x16x32_bf16 v[136:139], a[72:75], a[168:171], v[136:139]
    v_max3_f32 v226, v226, v114, v115
    v_mfma_f32_16x16x32_bf16 v[140:143], a[72:75], a[184:187], v[140:143]
    v_max3_f32 v227, v227, v118, v119
    v_mfma_f32_16x16x32_bf16 v[144:147], a[72:75], a[200:203], v[144:147]
    v_max3_f32 v228, v228, v122, v123
    v_mfma_f32_16x16x32_bf16 v[148:151], a[72:75], a[216:219], v[148:151]
    v_max3_f32 v229, v229, v126, v127
    v_mfma_f32_16x16x32_bf16 v[128:131], a[76:79], a[140:143], v[128:131]
    v_mfma_f32_16x16x32_bf16 v[132:135], a[76:79], a[156:159], v[132:135]
    v_mfma_f32_16x16x32_bf16 v[136:139], a[76:79], a[172:175], v[136:139]
    v_mfma_f32_16x16x32_bf16 v[140:143], a[76:79], a[188:191], v[140:143]
    v_mfma_f32_16x16x32_bf16 v[144:147], a[76:79], a[204:207], v[144:147]
    v_mfma_f32_16x16x32_bf16 v[148:151], a[76:79], a[220:223], v[148:151]
    s_waitcnt vmcnt(14)
    v_mfma_f32_16x16x32_bf16 v[152:155], a[80:83], a[128:131], 0
    v_mfma_f32_16x16x32_bf16 v[156:159], a[80:83], a[144:147], 0
    v_mfma_f32_16x16x32_bf16 v[160:163], a[80:83], a[160:163], 0
    s_add_u32 m0, s57, 2048
    s_add_u32 s55, s56, 4096
    buffer_load_dwordx4 v20, s[16:19], s55 offen nt lds
    v_mfma_f32_16x16x32_bf16 v[164:167], a[80:83], a[176:179], 0
    v_mfma_f32_16x16x32_bf16 v[168:171], a[80:83], a[192:195], 0
    v_mfma_f32_16x16x32_bf16 v[172:175], a[80:83], a[208:211], 0
    v_mfma_f32_16x16x32_bf16 v[152:155], a[84:87], a[132:135], v[152:155]
    v_max3_f32 v224, v224, v128, v129
    v_mfma_f32_16x16x32_bf16 v[156:159], a[84:87], a[148:151], v[156:159]
    v_max3_f32 v225, v225, v132, v133
    v_mfma_f32_16x16x32_bf16 v[160:163], a[84:87], a[164:167], v[160:163]
    v_max3_f32 v226, v226, v136, v137
    v_mfma_f32_16x16x32_bf16 v[164:167], a[84:87], a[180:183], v[164:167]
    v_max3_f32 v227, v227, v140, v141
    v_mfma_f32_16x16x32_bf16 v[168:171], a[84:87], a[196:199], v[168:171]
    v_max3_f32 v228, v228, v144, v145
    v_mfma_f32_16x16x32_bf16 v[172:175], a[84:87], a[212:215], v[172:175]
    v_max3_f32 v229, v229, v148, v149
    v_mfma_f32_16x16x32_bf16 v[152:155], a[88:91], a[136:139], v[152:155]
    v_max3_f32 v224, v224, v130, v131
    v_mfma_f32_16x16x32_bf16 v[156:159], a[88:91], a[152:155], v[156:159]
    v_max3_f32 v225, v225, v134, v135
    v_mfma_f32_16x16x32_bf16 v[160:163], a[88:91], a[168:171], v[160:163]
    v_max3_f32 v226, v226, v138, v139
    v_mfma_f32_16x16x32_bf16 v[164:167], a[88:91], a[184:187], v[164:167]
    v_max3_f32 v227, v227, v142, v143
    v_mfma_f32_16x16x32_bf16 v[168:171], a[88:91], a[200:203], v[168:171]
    v_max3_f32 v228, v228, v146, v147
    v_mfma_f32_16x16x32_bf16 v[172:175], a[88:91], a[216:219], v[172:175]
    v_max3_f32 v229, v229, v150, v151
    v_mfma_f32_16x16x32_bf16 v[152:155], a[92:95], a[140:143], v[152:155]
    v_mfma_f32_16x16x32_bf16 v[156:159], a[92:95], a[156:159], v[156:159]
    v_mfma_f32_16x16x32_bf16 v[160:163], a[92:95], a[172:175], v[160:163]
    v_mfma_f32_16x16x32_bf16 v[164:167], a[92:95], a[188:191], v[164:167]
    v_mfma_f32_16x16x32_bf16 v[168:171], a[92:95], a[204:207], v[168:171]
    v_mfma_f32_16x16x32_bf16 v[172:175], a[92:95], a[220:223], v[172:175]
    s_waitcnt vmcnt(11)
    v_mfma_f32_16x16x32_bf16 v[176:179], a[96:99], a[128:131], 0
    v_mfma_f32_16x16x32_bf16 v[180:183], a[96:99], a[144:147], 0
    v_mfma_f32_16x16x32_bf16 v[184:187], a[96:99], a[160:163], 0
    s_add_u32 m0, s57, 3072
    s_add_u32 s55, s56, 6144
    buffer_load_dwordx4 v20, s[16:19], s55 offen nt lds
    v_mfma_f32_16x16x32_bf16 v[188:191], a[96:99], a[176:179], 0
    v_mfma_f32_16x16x32_bf16 v[192:195], a[96:99], a[192:195], 0
    v_mfma_f32_16x16x32_bf16 v[196:199], a[96:99], a[208:211], 0
    v_mfma_f32_16x16x32_bf16 v[176:179], a[100:103], a[132:135], v[176:179]
    v_max3_f32 v224, v224, v152, v153
    v_mfma_f32_16x16x32_bf16 v[180:183], a[100:103], a[148:151], v[180:183]
    v_max3_f32 v225, v225, v156, v157
    v_mfma_f32_16x16x32_bf16 v[184:187], a[100:103], a[164:167], v[184:187]
    v_max3_f32 v226, v226, v160, v161
    v_mfma_f32_16x16x32_bf16 v[188:191], a[100:103], a[180:183], v[188:191]
    v_max3_f32 v227, v227, v164, v165
    v_mfma_f32_16x16x32_bf16 v[192:195], a[100:103], a[196:199], v[192:195]
    v_max3_f32 v228, v228, v168, v169
    v_mfma_f32_16x16x32_bf16 v[196:199], a[100:103], a[212:215], v[196:199]
    v_max3_f32 v229, v229, v172, v173
    v_mfma_f32_16x16x32_bf16 v[176:179], a[104:107], a[136:139], v[176:179]
    v_max3_f32 v224, v224, v154, v155
    v_mfma_f32_16x16x32_bf16 v[180:183], a[104:107], a[152:155], v[180:183]
    v_max3_f32 v225, v225, v158, v159
    v_mfma_f32_16x16x32_bf16 v[184:187], a[104:107], a[168:171], v[184:187]
    v_max3_f32 v226, v226, v162, v163
    v_mfma_f32_16x16x32_bf16 v[188:191], a[104:107], a[184:187], v[188:191]
    v_max3_f32 v227, v227, v166, v167
    v_mfma_f32_16x16x32_bf16 v[192:195], a[104:107], a[200:203], v[192:195]
    v_max3_f32 v228, v228, v170, v171
    v_mfma_f32_16x16x32_bf16 v[196:199], a[104:107], a[216:219], v[196:199]
    v_max3_f32 v229, v229, v174, v175
    v_mfma_f32_16x16x32_bf16 v[176:179], a[108:111], a[140:143], v[176:179]
    v_mfma_f32_16x16x32_bf16 v[180:183], a[108:111], a[156:159], v[180:183]
    v_mfma_f32_16x16x32_bf16 v[184:187], a[108:111], a[172:175], v[184:187]
    v_mfma_f32_16x16x32_bf16 v[188:191], a[108:111], a[188:191], v[188:191]
    v_mfma_f32_16x16x32_bf16 v[192:195], a[108:111], a[204:207], v[192:195]
    v_mfma_f32_16x16x32_bf16 v[196:199], a[108:111], a[220:223], v[196:199]
    s_waitcnt vmcnt(4)
    v_mfma_f32_16x16x32_bf16 v[200:203], a[112:115], a[128:131], 0
    v_mfma_f32_16x16x32_bf16 v[204:207], a[112:115], a[144:147], 0
    v_mfma_f32_16x16x32_bf16 v[208:211], a[112:115], a[160:163], 0
    s_add_u32 m0, s57, 4096
    s_add_u32 s55, s56, 8192
    buffer_load_dwordx4 v20, s[16:19], s55 offen nt lds
    v_mfma_f32_16x16x32_bf16 v[212:215], a[112:115], a[176:179], 0
    v_mfma_f32_16x16x32_bf16 v[216:219], a[112:115], a[192:195], 0
    v_mfma_f32_16x16x32_bf16 v[220:223], a[112:115], a[208:211], 0
    v_mfma_f32_16x16x32_bf16 v[200:203], a[116:119], a[132:135], v[200:203]
    v_max3_f32 v224, v224, v176, v177
    v_mfma_f32_16x16x32_bf16 v[204:207], a[116:119], a[148:151], v[204:207]
    v_max3_f32 v225, v225, v180, v181
    v_mfma_f32_16x16x32_bf16 v[208:211], a[116:119], a[164:167], v[208:211]
    v_max3_f32 v226, v226, v184, v185
    v_mfma_f32_16x16x32_bf16 v[212:215], a[116:119], a[180:183], v[212:215]
    v_max3_f32 v227, v227, v188, v189
    v_mfma_f32_16x16x32_bf16 v[216:219], a[116:119], a[196:199], v[216:219]
    v_max3_f32 v228, v228, v192, v193
    v_mfma_f32_16x16x32_bf16 v[220:223], a[116:119], a[212:215], v[220:223]
    v_max3_f32 v229, v229, v196, v197
    v_mfma_f32_16x16x32_bf16 v[200:203], a[120:123], a[136:139], v[200:203]
    v_max3_f32 v224, v224, v178, v179
    v_mfma_f32_16x16x32_bf16 v[204:207], a[120:123], a[152:155], v[204:207]
    v_max3_f32 v225, v225, v182, v183
    v_mfma_f32_16x16x32_bf16 v[208:211], a[120:123], a[168:171], v[208:211]
    v_max3_f32 v226, v226, v186, v187
    v_mfma_f32_16x16x32_bf16 v[212:215], a[120:123], a[184:187], v[212:215]
    v_max3_f32 v227, v227, v190, v191
    v_mfma_f32_16x16x32_bf16 v[216:219], a[120:123], a[200:203], v[216:219]
    v_max3_f32 v228, v228, v194, v195
    v_mfma_f32_16x16x32_bf16 v[220:223], a[120:123], a[216:219], v[220:223]
    v_max3_f32 v229, v229, v198, v199
    v_mfma_f32_16x16x32_bf16 v[200:203], a[124:127], a[140:143], v[200:203]
    v_mfma_f32_16x16x32_bf16 v[204:207], a[124:127], a[156:159], v[204:207]
    v_mfma_f32_16x16x32_bf16 v[208:211], a[124:127], a[172:175], v[208:211]
    v_mfma_f32_16x16x32_bf16 v[212:215], a[124:127], a[188:191], v[212:215]
    v_mfma_f32_16x16x32_bf16 v[216:219], a[124:127], a[204:207], v[216:219]
    v_mfma_f32_16x16x32_bf16 v[220:223], a[124:127], a[220:223], v[220:223]
    s_nop 7
    v_max3_f32 v224, v224, v200, v201
    v_max3_f32 v224, v224, v202, v203
    v_max3_f32 v225, v225, v204, v205
    v_max3_f32 v225, v225, v206, v207
    v_max3_f32 v226, v226, v208, v209
    v_max3_f32 v226, v226, v210, v211
    v_max3_f32 v227, v227, v212, v213
    v_max3_f32 v227, v227, v214, v215
    v_max3_f32 v228, v228, v216, v217
    v_max3_f32 v228, v228, v218, v219
    v_max3_f32 v229, v229, v220, v221
    v_max3_f32 v229, v229, v222, v223
    v_mov_b32 v236, v224
    v_mov_b32 v237, v225
    v_mov_b32 v238, v226
    v_mov_b32 v239, v227
    v_mov_b32 v240, v228
    v_mov_b32 v241, v229
    s_nop 1
    v_permlane32_swap_b32 v224, v236
    v_permlane32_swap_b32 v225, v237
    v_permlane32_swap_b32 v226, v238
    v_permlane32_swap_b32 v227, v239
    v_permlane32_swap_b32 v228, v240
    v_permlane32_swap_b32 v229, v241
    s_nop 1
    v_max_f32 v224, v224, v236
    v_max_f32 v225, v225, v237
    v_max_f32 v226, v226, v238
    v_max_f32 v227, v227, v239
    v_max_f32 v228, v228, v240
    v_max_f32 v229, v229, v241
    v_mov_b32 v236, v224
    v_mov_b32 v237, v225
    v_mov_b32 v238, v226
    v_mov_b32 v239, v227
    v_mov_b32 v240, v228
    v_mov_b32 v241, v229
    s_nop 1
    v_permlane16_swap_b32 v224, v236
    v_permlane16_swap_b32 v225, v237
    v_permlane16_swap_b32 v226, v238
    v_permlane16_swap_b32 v227, v239
    v_permlane16_swap_b32 v228, v240
    v_permlane16_swap_b32 v229, v241
    s_nop 1
    v_max_f32 v224, v224, v236
    v_max_f32 v225, v225, v237
    v_max_f32 v226, v226, v238
    v_max_f32 v227, v227, v239
    v_max_f32 v228, v228, v240
    v_max_f32 v229, v229, v241
    ds_write_b32 v27, v224 offset:0
    ds_write_b32 v27, v225 offset:256
    ds_write_b32 v27, v226 offset:512
    ds_write_b32 v27, v227 offset:768
    ds_write_b32 v27, v228 offset:1024
    ds_write_b32 v27, v229 offset:1280
    s_waitcnt lgkmcnt(0)
    s_barrier
    v_readfirstlane_b32 s6, v7
    s_mov_b32 s55, 0
L_tagpoll:
    s_cmp_lg_u32 s6, 0
    s_cbranch_scc1 L_tagok
    buffer_load_dword v7, v19, s[36:39], 0 offen sc1
    s_waitcnt vmcnt(0)
    v_readfirstlane_b32 s6, v7
    s_add_u32 s55, s55, 1
    s_cmp_lt_u32 s55, 200000
    s_cbranch_scc1 L_tagpoll
L_tagok:
    s_cmp_lg_u32 s40, 0
    s_cbranch_scc1 L_sigw
    s_and_b32 s43, s2, 7
    s_lshl_b32 s43, s43, 7
    s_lshr_b32 s44, s2, 3
    s_lshl_b32 s44, s44, 2
    s_add_u32 s43, s43, s44
    s_add_u32 s43, s43, 10489856
    v_mov_b32 v30, s6
    v_mov_b32 v31, 0
    s_mov_b64 exec, 1
    buffer_store_dword v30, v31, s[32:35], s43 offen sc1
    s_mov_b64 exec, -1
L_sigw:
    ds_read_b128 v[236:239], v28 offset:0
    ds_read_b128 v[240:243], v28 offset:256
    ds_read_b128 v[244:247], v28 offset:512
    ds_read_b128 v[248:251], v28 offset:768
    ds_read_b128 v[252:255], v28 offset:1024
    ds_read_b128 v[12:15], v28 offset:1280
    s_waitcnt lgkmcnt(0)
    v_max3_f32 v236, v236, v237, v238
    v_max_f32 v236, v236, v239
    v_mul_f32 v224, s49, v236
    v_mul_f32 v225, s49, v236
    v_max3_f32 v240, v240, v241, v242
    v_max_f32 v240, v240, v243
    v_mul_f32 v226, s49, v240
    v_mul_f32 v227, s49, v240
    v_max3_f32 v244, v244, v245, v246
    v_max_f32 v244, v244, v247
    v_mul_f32 v228, s49, v244
    v_mul_f32 v229, s49, v244
    v_max3_f32 v248, v248, v249, v250
    v_max_f32 v248, v248, v251
    v_mul_f32 v230, s49, v248
    v_mul_f32 v231, s49, v248
    v_max3_f32 v252, v252, v253, v254
    v_max_f32 v252, v252, v255
    v_mul_f32 v232, s49, v252
    v_mul_f32 v233, s49, v252
    v_max3_f32 v12, v12, v13, v14
    v_max_f32 v12, v12, v15
    v_mul_f32 v234, s49, v12
    v_mul_f32 v235, s49, v12
    s_mov_b32 s66, s49
    s_mov_b32 s67, s49
    v_mov_b32 v30, 0x3f803f80
    v_accvgpr_write_b32 a96, v30
    v_accvgpr_write_b32 a97, v30
    v_accvgpr_write_b32 a98, v30
    v_accvgpr_write_b32 a99, v30
    v_pk_fma_f32 v[32:33], v[32:33], s[66:67], v[224:225] neg_lo:[0,0,1] neg_hi:[0,0,1]
    v_pk_fma_f32 v[34:35], v[34:35], s[66:67], v[224:225] neg_lo:[0,0,1] neg_hi:[0,0,1]
    v_pk_fma_f32 v[56:57], v[56:57], s[66:67], v[224:225] neg_lo:[0,0,1] neg_hi:[0,0,1]
    v_pk_fma_f32 v[58:59], v[58:59], s[66:67], v[224:225] neg_lo:[0,0,1] neg_hi:[0,0,1]
    s_add_u32 m0, s57, 5120
    s_add_u32 s55, s56, 10240
    buffer_load_dwordx4 v20, s[16:19], s55 offen nt lds
    v_exp_f32 v32, v32
    v_exp_f32 v33, v33
    v_exp_f32 v34, v34
    v_exp_f32 v35, v35
    v_exp_f32 v56, v56
    v_exp_f32 v57, v57
    v_exp_f32 v58, v58
    v_exp_f32 v59, v59
    s_nop 0
    v_cvt_pk_bf16_f32 v32, v32, v33
    v_cvt_pk_bf16_f32 v33, v34, v35
    v_cvt_pk_bf16_f32 v34, v56, v57
    v_cvt_pk_bf16_f32 v35, v58, v59
    v_pk_fma_f32 v[80:81], v[80:81], s[66:67], v[224:225] neg_lo:[0,0,1] neg_hi:[0,0,1]
    v_pk_fma_f32 v[82:83], v[82:83], s[66:67], v[224:225] neg_lo:[0,0,1] neg_hi:[0,0,1]
    v_pk_fma_f32 v[104:105], v[104:105], s[66:67], v[224:225] neg_lo:[0,0,1] neg_hi:[0,0,1]
    v_pk_fma_f32 v[106:107], v[106:107], s[66:67], v[224:225] neg_lo:[0,0,1] neg_hi:[0,0,1]
    v_mfma_f32_16x16x32_bf16 a[112:115], a[96:99], v[32:35], 0
    s_add_u32 m0, s57, 6144
    s_add_u32 s55, s56, 12288
    buffer_load_dwordx4 v20, s[16:19], s55 offen nt lds
    v_exp_f32 v80, v80
    v_exp_f32 v81, v81
    v_exp_f32 v82, v82
    v_exp_f32 v83, v83
    v_exp_f32 v104, v104
    v_exp_f32 v105, v105
    v_exp_f32 v106, v106
    v_exp_f32 v107, v107
    s_nop 0
    v_cvt_pk_bf16_f32 v80, v80, v81
    v_cvt_pk_bf16_f32 v81, v82, v83
    v_cvt_pk_bf16_f32 v82, v104, v105
    v_cvt_pk_bf16_f32 v83, v106, v107
    v_pk_fma_f32 v[128:129], v[128:129], s[66:67], v[224:225] neg_lo:[0,0,1] neg_hi:[0,0,1]
    v_pk_fma_f32 v[130:131], v[130:131], s[66:67], v[224:225] neg_lo:[0,0,1] neg_hi:[0,0,1]
    v_pk_fma_f32 v[152:153], v[152:153], s[66:67], v[224:225] neg_lo:[0,0,1] neg_hi:[0,0,1]
    v_pk_fma_f32 v[154:155], v[154:155], s[66:67], v[224:225] neg_lo:[0,0,1] neg_hi:[0,0,1]
    v_mfma_f32_16x16x32_bf16 a[112:115], a[96:99], v[80:83], a[112:115]
    s_add_u32 m0, s57, 7168
    s_add_u32 s55, s56, 14336
    buffer_load_dwordx4 v20, s[16:19], s55 offen nt lds
    v_exp_f32 v128, v128
    v_exp_f32 v129, v129
    v_exp_f32 v130, v130
    v_exp_f32 v131, v131
    v_exp_f32 v152, v152
    v_exp_f32 v153, v153
    v_exp_f32 v154, v154
    v_exp_f32 v155, v155
    s_nop 0
    v_cvt_pk_bf16_f32 v128, v128, v129
    v_cvt_pk_bf16_f32 v129, v130, v131
    v_cvt_pk_bf16_f32 v130, v152, v153
    v_cvt_pk_bf16_f32 v131, v154, v155
    v_pk_fma_f32 v[176:177], v[176:177], s[66:67], v[224:225] neg_lo:[0,0,1] neg_hi:[0,0,1]
    v_pk_fma_f32 v[178:179], v[178:179], s[66:67], v[224:225] neg_lo:[0,0,1] neg_hi:[0,0,1]
    v_pk_fma_f32 v[200:201], v[200:201], s[66:67], v[224:225] neg_lo:[0,0,1] neg_hi:[0,0,1]
    v_pk_fma_f32 v[202:203], v[202:203], s[66:67], v[224:225] neg_lo:[0,0,1] neg_hi:[0,0,1]
    v_mfma_f32_16x16x32_bf16 a[112:115], a[96:99], v[128:131], a[112:115]
    s_add_u32 m0, s57, 8192
    s_add_u32 s55, s56, 16384
    buffer_load_dwordx4 v20, s[16:19], s55 offen nt lds
    v_exp_f32 v176, v176
    v_exp_f32 v177, v177
    v_exp_f32 v178, v178
    v_exp_f32 v179, v179
    v_exp_f32 v200, v200
    v_exp_f32 v201, v201
    v_exp_f32 v202, v202
    v_exp_f32 v203, v203
    s_nop 0
    v_cvt_pk_bf16_f32 v176, v176, v177
    v_cvt_pk_bf16_f32 v177, v178, v179
    v_cvt_pk_bf16_f32 v178, v200, v201
    v_cvt_pk_bf16_f32 v179, v202, v203
    v_pk_fma_f32 v[36:37], v[36:37], s[66:67], v[226:227] neg_lo:[0,0,1] neg_hi:[0,0,1]
    v_pk_fma_f32 v[38:39], v[38:39], s[66:67], v[226:227] neg_lo:[0,0,1] neg_hi:[0,0,1]
    v_pk_fma_f32 v[60:61], v[60:61], s[66:67], v[226:227] neg_lo:[0,0,1] neg_hi:[0,0,1]
    v_pk_fma_f32 v[62:63], v[62:63], s[66:67], v[226:227] neg_lo:[0,0,1] neg_hi:[0,0,1]
    v_mfma_f32_16x16x32_bf16 a[112:115], a[96:99], v[176:179], a[112:115]
    s_add_u32 m0, s57, 9216
    s_add_u32 s55, s56, 18432
    buffer_load_dwordx4 v20, s[16:19], s55 offen nt lds
    v_exp_f32 v36, v36
    v_exp_f32 v37, v37
    v_exp_f32 v38, v38
    v_exp_f32 v39, v39
    v_exp_f32 v60, v60
    v_exp_f32 v61, v61
    v_exp_f32 v62, v62
    v_exp_f32 v63, v63
    s_nop 0
    v_cvt_pk_bf16_f32 v36, v36, v37
    v_cvt_pk_bf16_f32 v37, v38, v39
    v_cvt_pk_bf16_f32 v38, v60, v61
    v_cvt_pk_bf16_f32 v39, v62, v63
    v_pk_fma_f32 v[84:85], v[84:85], s[66:67], v[226:227] neg_lo:[0,0,1] neg_hi:[0,0,1]
    v_pk_fma_f32 v[86:87], v[86:87], s[66:67], v[226:227] neg_lo:[0,0,1] neg_hi:[0,0,1]
    v_pk_fma_f32 v[108:109], v[108:109], s[66:67], v[226:227] neg_lo:[0,0,1] neg_hi:[0,0,1]
    v_pk_fma_f32 v[110:111], v[110:111], s[66:67], v[226:227] neg_lo:[0,0,1] neg_hi:[0,0,1]
    v_mfma_f32_16x16x32_bf16 a[116:119], a[96:99], v[36:39], 0
    s_add_u32 m0, s57, 10240
    s_add_u32 s55, s56, 20480
    buffer_load_dwordx4 v20, s[16:19], s55 offen nt lds
    v_exp_f32 v84, v84
    v_exp_f32 v85, v85
    v_exp_f32 v86, v86
    v_exp_f32 v87, v87
    v_exp_f32 v108, v108
    v_exp_f32 v109, v109
    v_exp_f32 v110, v110
    v_exp_f32 v111, v111
    s_nop 0
    v_cvt_pk_bf16_f32 v84, v84, v85
    v_cvt_pk_bf16_f32 v85, v86, v87
    v_cvt_pk_bf16_f32 v86, v108, v109
    v_cvt_pk_bf16_f32 v87, v110, v111
    v_pk_fma_f32 v[132:133], v[132:133], s[66:67], v[226:227] neg_lo:[0,0,1] neg_hi:[0,0,1]
    v_pk_fma_f32 v[134:135], v[134:135], s[66:67], v[226:227] neg_lo:[0,0,1] neg_hi:[0,0,1]
    v_pk_fma_f32 v[156:157], v[156:157], s[66:67], v[226:227] neg_lo:[0,0,1] neg_hi:[0,0,1]
    v_pk_fma_f32 v[158:159], v[158:159], s[66:67], v[226:227] neg_lo:[0,0,1] neg_hi:[0,0,1]
    v_mfma_f32_16x16x32_bf16 a[116:119], a[96:99], v[84:87], a[116:119]
    s_add_u32 m0, s57, 11264
    s_add_u32 s55, s56, 22528
    buffer_load_dwordx4 v20, s[16:19], s55 offen nt lds
    v_exp_f32 v132, v132
    v_exp_f32 v133, v133
    v_exp_f32 v134, v134
    v_exp_f32 v135, v135
    v_exp_f32 v156, v156
    v_exp_f32 v157, v157
    v_exp_f32 v158, v158
    v_exp_f32 v159, v159
    s_nop 0
    v_cvt_pk_bf16_f32 v132, v132, v133
    v_cvt_pk_bf16_f32 v133, v134, v135
    v_cvt_pk_bf16_f32 v134, v156, v157
    v_cvt_pk_bf16_f32 v135, v158, v159
    v_pk_fma_f32 v[180:181], v[180:181], s[66:67], v[226:227] neg_lo:[0,0,1] neg_hi:[0,0,1]
    v_pk_fma_f32 v[182:183], v[182:183], s[66:67], v[226:227] neg_lo:[0,0,1] neg_hi:[0,0,1]
    v_pk_fma_f32 v[204:205], v[204:205], s[66:67], v[226:227] neg_lo:[0,0,1] neg_hi:[0,0,1]
    v_pk_fma_f32 v[206:207], v[206:207], s[66:67], v[226:227] neg_lo:[0,0,1] neg_hi:[0,0,1]
    v_mfma_f32_16x16x32_bf16 a[116:119], a[96:99], v[132:135], a[116:119]
    s_add_u32 m0, s57, 12288
    s_add_u32 s55, s56, 24576
    buffer_load_dwordx4 v20, s[16:19], s55 offen nt lds
    v_exp_f32 v180, v180
    v_exp_f32 v181, v181
    v_exp_f32 v182, v182
    v_exp_f32 v183, v183
    v_exp_f32 v204, v204
    v_exp_f32 v205, v205
    v_exp_f32 v206, v206
    v_exp_f32 v207, v207
    s_nop 0
    v_cvt_pk_bf16_f32 v180, v180, v181
    v_cvt_pk_bf16_f32 v181, v182, v183
    v_cvt_pk_bf16_f32 v182, v204, v205
    v_cvt_pk_bf16_f32 v183, v206, v207
    v_pk_fma_f32 v[40:41], v[40:41], s[66:67], v[228:229] neg_lo:[0,0,1] neg_hi:[0,0,1]
    v_pk_fma_f32 v[42:43], v[42:43], s[66:67], v[228:229] neg_lo:[0,0,1] neg_hi:[0,0,1]
    v_pk_fma_f32 v[64:65], v[64:65], s[66:67], v[228:229] neg_lo:[0,0,1] neg_hi:[0,0,1]
    v_pk_fma_f32 v[66:67], v[66:67], s[66:67], v[228:229] neg_lo:[0,0,1] neg_hi:[0,0,1]
    v_mfma_f32_16x16x32_bf16 a[116:119], a[96:99], v[180:183], a[116:119]
    s_add_u32 m0, s57, 13312
    s_add_u32 s55, s56, 26624
    buffer_load_dwordx4 v20, s[16:19], s55 offen nt lds
    v_exp_f32 v40, v40
    v_exp_f32 v41, v41
    v_exp_f32 v42, v42
    v_exp_f32 v43, v43
    v_exp_f32 v64, v64
    v_exp_f32 v65, v65
    v_exp_f32 v66, v66
    v_exp_f32 v67, v67
    s_nop 0
    v_cvt_pk_bf16_f32 v40, v40, v41
    v_cvt_pk_bf16_f32 v41, v42, v43
    v_cvt_pk_bf16_f32 v42, v64, v65
    v_cvt_pk_bf16_f32 v43, v66, v67
    v_pk_fma_f32 v[88:89], v[88:89], s[66:67], v[228:229] neg_lo:[0,0,1] neg_hi:[0,0,1]
    v_pk_fma_f32 v[90:91], v[90:91], s[66:67], v[228:229] neg_lo:[0,0,1] neg_hi:[0,0,1]
    v_pk_fma_f32 v[112:113], v[112:113], s[66:67], v[228:229] neg_lo:[0,0,1] neg_hi:[0,0,1]
    v_pk_fma_f32 v[114:115], v[114:115], s[66:67], v[228:229] neg_lo:[0,0,1] neg_hi:[0,0,1]
    v_mfma_f32_16x16x32_bf16 a[120:123], a[96:99], v[40:43], 0
    s_add_u32 m0, s57, 14336
    s_add_u32 s55, s56, 28672
    buffer_load_dwordx4 v20, s[16:19], s55 offen nt lds
    v_exp_f32 v88, v88
    v_exp_f32 v89, v89
    v_exp_f32 v90, v90
    v_exp_f32 v91, v91
    v_exp_f32 v112, v112
    v_exp_f32 v113, v113
    v_exp_f32 v114, v114
    v_exp_f32 v115, v115
    s_nop 0
    v_cvt_pk_bf16_f32 v88, v88, v89
    v_cvt_pk_bf16_f32 v89, v90, v91
    v_cvt_pk_bf16_f32 v90, v112, v113
    v_cvt_pk_bf16_f32 v91, v114, v115
    v_pk_fma_f32 v[136:137], v[136:137], s[66:67], v[228:229] neg_lo:[0,0,1] neg_hi:[0,0,1]
    v_pk_fma_f32 v[138:139], v[138:139], s[66:67], v[228:229] neg_lo:[0,0,1] neg_hi:[0,0,1]
    v_pk_fma_f32 v[160:161], v[160:161], s[66:67], v[228:229] neg_lo:[0,0,1] neg_hi:[0,0,1]
    v_pk_fma_f32 v[162:163], v[162:163], s[66:67], v[228:229] neg_lo:[0,0,1] neg_hi:[0,0,1]
    v_mfma_f32_16x16x32_bf16 a[120:123], a[96:99], v[88:91], a[120:123]
    s_add_u32 m0, s57, 15360
    s_add_u32 s55, s56, 30720
    buffer_load_dwordx4 v20, s[16:19], s55 offen nt lds
    v_exp_f32 v136, v136
    v_exp_f32 v137, v137
    v_exp_f32 v138, v138
    v_exp_f32 v139, v139
    v_exp_f32 v160, v160
    v_exp_f32 v161, v161
    v_exp_f32 v162, v162
    v_exp_f32 v163, v163
    s_nop 0
    v_cvt_pk_bf16_f32 v136, v136, v137
    v_cvt_pk_bf16_f32 v137, v138, v139
    v_cvt_pk_bf16_f32 v138, v160, v161
    v_cvt_pk_bf16_f32 v139, v162, v163
    v_pk_fma_f32 v[184:185], v[184:185], s[66:67], v[228:229] neg_lo:[0,0,1] neg_hi:[0,0,1]
    v_pk_fma_f32 v[186:187], v[186:187], s[66:67], v[228:229] neg_lo:[0,0,1] neg_hi:[0,0,1]
    v_pk_fma_f32 v[208:209], v[208:209], s[66:67], v[228:229] neg_lo:[0,0,1] neg_hi:[0,0,1]
    v_pk_fma_f32 v[210:211], v[210:211], s[66:67], v[228:229] neg_lo:[0,0,1] neg_hi:[0,0,1]
    v_mfma_f32_16x16x32_bf16 a[120:123], a[96:99], v[136:139], a[120:123]
    v_exp_f32 v184, v184
    v_exp_f32 v185, v185
    v_exp_f32 v186, v186
    v_exp_f32 v187, v187
    v_exp_f32 v208, v208
    v_exp_f32 v209, v209
    v_exp_f32 v210, v210
    v_exp_f32 v211, v211
    s_nop 0
    v_cvt_pk_bf16_f32 v184, v184, v185
    v_cvt_pk_bf16_f32 v185, v186, v187
    v_cvt_pk_bf16_f32 v186, v208, v209
    v_cvt_pk_bf16_f32 v187, v210, v211
    v_pk_fma_f32 v[44:45], v[44:45], s[66:67], v[230:231] neg_lo:[0,0,1] neg_hi:[0,0,1]
    v_pk_fma_f32 v[46:47], v[46:47], s[66:67], v[230:231] neg_lo:[0,0,1] neg_hi:[0,0,1]
    v_pk_fma_f32 v[68:69], v[68:69], s[66:67], v[230:231] neg_lo:[0,0,1] neg_hi:[0,0,1]
    v_pk_fma_f32 v[70:71], v[70:71], s[66:67], v[230:231] neg_lo:[0,0,1] neg_hi:[0,0,1]
    v_mfma_f32_16x16x32_bf16 a[120:123], a[96:99], v[184:187], a[120:123]
    s_lshr_b32 s56, s40, 1
    s_lshl_b32 s56, s56, 7
    s_add_u32 s56, s56, s47
    s_add_u32 m0, s57, 16384
    s_add_u32 s55, s56, 0
    buffer_load_dwordx4 v20, s[16:19], s55 offen nt lds
    v_exp_f32 v44, v44
    v_exp_f32 v45, v45
    v_exp_f32 v46, v46
    v_exp_f32 v47, v47
    v_exp_f32 v68, v68
    v_exp_f32 v69, v69
    v_exp_f32 v70, v70
    v_exp_f32 v71, v71
    s_nop 0
    v_cvt_pk_bf16_f32 v44, v44, v45
    v_cvt_pk_bf16_f32 v45, v46, v47
    v_cvt_pk_bf16_f32 v46, v68, v69
    v_cvt_pk_bf16_f32 v47, v70, v71
    v_pk_fma_f32 v[92:93], v[92:93], s[66:67], v[230:231] neg_lo:[0,0,1] neg_hi:[0,0,1]
    v_pk_fma_f32 v[94:95], v[94:95], s[66:67], v[230:231] neg_lo:[0,0,1] neg_hi:[0,0,1]
    v_pk_fma_f32 v[116:117], v[116:117], s[66:67], v[230:231] neg_lo:[0,0,1] neg_hi:[0,0,1]
    v_pk_fma_f32 v[118:119], v[118:119], s[66:67], v[230:231] neg_lo:[0,0,1] neg_hi:[0,0,1]
    v_mfma_f32_16x16x32_bf16 a[124:127], a[96:99], v[44:47], 0
    v_exp_f32 v92, v92
    v_exp_f32 v93, v93
    v_exp_f32 v94, v94
    v_exp_f32 v95, v95
    v_exp_f32 v116, v116
    v_exp_f32 v117, v117
    v_exp_f32 v118, v118
    v_exp_f32 v119, v119
    s_nop 0
    v_cvt_pk_bf16_f32 v92, v92, v93
    v_cvt_pk_bf16_f32 v93, v94, v95
    v_cvt_pk_bf16_f32 v94, v116, v117
    v_cvt_pk_bf16_f32 v95, v118, v119
    v_pk_fma_f32 v[140:141], v[140:141], s[66:67], v[230:231] neg_lo:[0,0,1] neg_hi:[0,0,1]
    v_pk_fma_f32 v[142:143], v[142:143], s[66:67], v[230:231] neg_lo:[0,0,1] neg_hi:[0,0,1]
    v_pk_fma_f32 v[164:165], v[164:165], s[66:67], v[230:231] neg_lo:[0,0,1] neg_hi:[0,0,1]
    v_pk_fma_f32 v[166:167], v[166:167], s[66:67], v[230:231] neg_lo:[0,0,1] neg_hi:[0,0,1]
    v_mfma_f32_16x16x32_bf16 a[124:127], a[96:99], v[92:95], a[124:127]
    s_add_u32 m0, s57, 17408
    s_add_u32 s55, s56, 2048
    buffer_load_dwordx4 v20, s[16:19], s55 offen nt lds
    v_exp_f32 v140, v140
    v_exp_f32 v141, v141
    v_exp_f32 v142, v142
    v_exp_f32 v143, v143
    v_exp_f32 v164, v164
    v_exp_f32 v165, v165
    v_exp_f32 v166, v166
    v_exp_f32 v167, v167
    s_nop 0
    v_cvt_pk_bf16_f32 v140, v140, v141
    v_cvt_pk_bf16_f32 v141, v142, v143
    v_cvt_pk_bf16_f32 v142, v164, v165
    v_cvt_pk_bf16_f32 v143, v166, v167
    v_pk_fma_f32 v[188:189], v[188:189], s[66:67], v[230:231] neg_lo:[0,0,1] neg_hi:[0,0,1]
    v_pk_fma_f32 v[190:191], v[190:191], s[66:67], v[230:231] neg_lo:[0,0,1] neg_hi:[0,0,1]
    v_pk_fma_f32 v[212:213], v[212:213], s[66:67], v[230:231] neg_lo:[0,0,1] neg_hi:[0,0,1]
    v_pk_fma_f32 v[214:215], v[214:215], s[66:67], v[230:231] neg_lo:[0,0,1] neg_hi:[0,0,1]
    v_mfma_f32_16x16x32_bf16 a[124:127], a[96:99], v[140:143], a[124:127]
    v_exp_f32 v188, v188
    v_exp_f32 v189, v189
    v_exp_f32 v190, v190
    v_exp_f32 v191, v191
    v_exp_f32 v212, v212
    v_exp_f32 v213, v213
    v_exp_f32 v214, v214
    v_exp_f32 v215, v215
    s_nop 0
    v_cvt_pk_bf16_f32 v188, v188, v189
    v_cvt_pk_bf16_f32 v189, v190, v191
    v_cvt_pk_bf16_f32 v190, v212, v213
    v_cvt_pk_bf16_f32 v191, v214, v215
    v_pk_fma_f32 v[48:49], v[48:49], s[66:67], v[232:233] neg_lo:[0,0,1] neg_hi:[0,0,1]
    v_pk_fma_f32 v[50:51], v[50:51], s[66:67], v[232:233] neg_lo:[0,0,1] neg_hi:[0,0,1]
    v_pk_fma_f32 v[72:73], v[72:73], s[66:67], v[232:233] neg_lo:[0,0,1] neg_hi:[0,0,1]
    v_pk_fma_f32 v[74:75], v[74:75], s[66:67], v[232:233] neg_lo:[0,0,1] neg_hi:[0,0,1]
    v_mfma_f32_16x16x32_bf16 a[124:127], a[96:99], v[188:191], a[124:127]
    s_add_u32 m0, s57, 18432
    s_add_u32 s55, s56, 4096
    buffer_load_dwordx4 v20, s[16:19], s55 offen nt lds
    v_exp_f32 v48, v48
    v_exp_f32 v49, v49
    v_exp_f32 v50, v50
    v_exp_f32 v51, v51
    v_exp_f32 v72, v72
    v_exp_f32 v73, v73
    v_exp_f32 v74, v74
    v_exp_f32 v75, v75
    s_nop 0
    v_cvt_pk_bf16_f32 v48, v48, v49
    v_cvt_pk_bf16_f32 v49, v50, v51
    v_cvt_pk_bf16_f32 v50, v72, v73
    v_cvt_pk_bf16_f32 v51, v74, v75
    v_pk_fma_f32 v[96:97], v[96:97], s[66:67], v[232:233] neg_lo:[0,0,1] neg_hi:[0,0,1]
    v_pk_fma_f32 v[98:99], v[98:99], s[66:67], v[232:233] neg_lo:[0,0,1] neg_hi:[0,0,1]
    v_pk_fma_f32 v[120:121], v[120:121], s[66:67], v[232:233] neg_lo:[0,0,1] neg_hi:[0,0,1]
    v_pk_fma_f32 v[122:123], v[122:123], s[66:67], v[232:233] neg_lo:[0,0,1] neg_hi:[0,0,1]
    v_mfma_f32_16x16x32_bf16 a[128:131], a[96:99], v[48:51], 0
    v_exp_f32 v96, v96
    v_exp_f32 v97, v97
    v_exp_f32 v98, v98
    v_exp_f32 v99, v99
    v_exp_f32 v120, v120
    v_exp_f32 v121, v121
    v_exp_f32 v122, v122
    v_exp_f32 v123, v123
    s_nop 0
    v_cvt_pk_bf16_f32 v96, v96, v97
    v_cvt_pk_bf16_f32 v97, v98, v99
    v_cvt_pk_bf16_f32 v98, v120, v121
    v_cvt_pk_bf16_f32 v99, v122, v123
    v_pk_fma_f32 v[144:145], v[144:145], s[66:67], v[232:233] neg_lo:[0,0,1] neg_hi:[0,0,1]
    v_pk_fma_f32 v[146:147], v[146:147], s[66:67], v[232:233] neg_lo:[0,0,1] neg_hi:[0,0,1]
    v_pk_fma_f32 v[168:169], v[168:169], s[66:67], v[232:233] neg_lo:[0,0,1] neg_hi:[0,0,1]
    v_pk_fma_f32 v[170:171], v[170:171], s[66:67], v[232:233] neg_lo:[0,0,1] neg_hi:[0,0,1]
    v_mfma_f32_16x16x32_bf16 a[128:131], a[96:99], v[96:99], a[128:131]
    s_add_u32 m0, s57, 19456
    s_add_u32 s55, s56, 6144
    buffer_load_dwordx4 v20, s[16:19], s55 offen nt lds
    v_exp_f32 v144, v144
    v_exp_f32 v145, v145
    v_exp_f32 v146, v146
    v_exp_f32 v147, v147
    v_exp_f32 v168, v168
    v_exp_f32 v169, v169
    v_exp_f32 v170, v170
    v_exp_f32 v171, v171
    s_nop 0
    v_cvt_pk_bf16_f32 v144, v144, v145
    v_cvt_pk_bf16_f32 v145, v146, v147
    v_cvt_pk_bf16_f32 v146, v168, v169
    v_cvt_pk_bf16_f32 v147, v170, v171
    v_pk_fma_f32 v[192:193], v[192:193], s[66:67], v[232:233] neg_lo:[0,0,1] neg_hi:[0,0,1]
    v_pk_fma_f32 v[194:195], v[194:195], s[66:67], v[232:233] neg_lo:[0,0,1] neg_hi:[0,0,1]
    v_pk_fma_f32 v[216:217], v[216:217], s[66:67], v[232:233] neg_lo:[0,0,1] neg_hi:[0,0,1]
    v_pk_fma_f32 v[218:219], v[218:219], s[66:67], v[232:233] neg_lo:[0,0,1] neg_hi:[0,0,1]
    v_mfma_f32_16x16x32_bf16 a[128:131], a[96:99], v[144:147], a[128:131]
    v_exp_f32 v192, v192
    v_exp_f32 v193, v193
    v_exp_f32 v194, v194
    v_exp_f32 v195, v195
    v_exp_f32 v216, v216
    v_exp_f32 v217, v217
    v_exp_f32 v218, v218
    v_exp_f32 v219, v219
    s_nop 0
    v_cvt_pk_bf16_f32 v192, v192, v193
    v_cvt_pk_bf16_f32 v193, v194, v195
    v_cvt_pk_bf16_f32 v194, v216, v217
    v_cvt_pk_bf16_f32 v195, v218, v219
    v_pk_fma_f32 v[52:53], v[52:53], s[66:67], v[234:235] neg_lo:[0,0,1] neg_hi:[0,0,1]
    v_pk_fma_f32 v[54:55], v[54:55], s[66:67], v[234:235] neg_lo:[0,0,1] neg_hi:[0,0,1]
    v_pk_fma_f32 v[76:77], v[76:77], s[66:67], v[234:235] neg_lo:[0,0,1] neg_hi:[0,0,1]
    v_pk_fma_f32 v[78:79], v[78:79], s[66:67], v[234:235] neg_lo:[0,0,1] neg_hi:[0,0,1]
    v_mfma_f32_16x16x32_bf16 a[128:131], a[96:99], v[192:195], a[128:131]
    s_lshl_b32 s65, s52, 7
    s_lshl_b32 s55, s5, 6
    s_add_u32 s65, s65, s55
    s_add_u32 s63, s65, 10489856
    v_and_b32 v19, 15, v1
    v_lshlrev_b32 v19, 2, v19
    buffer_load_dword v7, v19, s[32:35], s63 offen sc1
    s_add_u32 m0, s57, 20480
    s_add_u32 s55, s56, 8192
    buffer_load_dwordx4 v20, s[16:19], s55 offen nt lds
    v_exp_f32 v52, v52
    v_exp_f32 v53, v53
    v_exp_f32 v54, v54
    v_exp_f32 v55, v55
    v_exp_f32 v76, v76
    v_exp_f32 v77, v77
    v_exp_f32 v78, v78
    v_exp_f32 v79, v79
    s_nop 0
    v_cvt_pk_bf16_f32 v52, v52, v53
    v_cvt_pk_bf16_f32 v53, v54, v55
    v_cvt_pk_bf16_f32 v54, v76, v77
    v_cvt_pk_bf16_f32 v55, v78, v79
    v_pk_fma_f32 v[100:101], v[100:101], s[66:67], v[234:235] neg_lo:[0,0,1] neg_hi:[0,0,1]
    v_pk_fma_f32 v[102:103], v[102:103], s[66:67], v[234:235] neg_lo:[0,0,1] neg_hi:[0,0,1]
    v_pk_fma_f32 v[124:125], v[124:125], s[66:67], v[234:235] neg_lo:[0,0,1] neg_hi:[0,0,1]
    v_pk_fma_f32 v[126:127], v[126:127], s[66:67], v[234:235] neg_lo:[0,0,1] neg_hi:[0,0,1]
    v_mfma_f32_16x16x32_bf16 a[132:135], a[96:99], v[52:55], 0
    v_exp_f32 v100, v100
    v_exp_f32 v101, v101
    v_exp_f32 v102, v102
    v_exp_f32 v103, v103
    v_exp_f32 v124, v124
    v_exp_f32 v125, v125
    v_exp_f32 v126, v126
    v_exp_f32 v127, v127
    s_nop 0
    v_cvt_pk_bf16_f32 v100, v100, v101
    v_cvt_pk_bf16_f32 v101, v102, v103
    v_cvt_pk_bf16_f32 v102, v124, v125
    v_cvt_pk_bf16_f32 v103, v126, v127
    v_pk_fma_f32 v[148:149], v[148:149], s[66:67], v[234:235] neg_lo:[0,0,1] neg_hi:[0,0,1]
    v_pk_fma_f32 v[150:151], v[150:151], s[66:67], v[234:235] neg_lo:[0,0,1] neg_hi:[0,0,1]
    v_pk_fma_f32 v[172:173], v[172:173], s[66:67], v[234:235] neg_lo:[0,0,1] neg_hi:[0,0,1]
    v_pk_fma_f32 v[174:175], v[174:175], s[66:67], v[234:235] neg_lo:[0,0,1] neg_hi:[0,0,1]
    v_mfma_f32_16x16x32_bf16 a[132:135], a[96:99], v[100:103], a[132:135]
    s_add_u32 m0, s57, 21504
    s_add_u32 s55, s56, 10240
    buffer_load_dwordx4 v20, s[16:19], s55 offen nt lds
    v_exp_f32 v148, v148
    v_exp_f32 v149, v149
    v_exp_f32 v150, v150
    v_exp_f32 v151, v151
    v_exp_f32 v172, v172
    v_exp_f32 v173, v173
    v_exp_f32 v174, v174
    v_exp_f32 v175, v175
    s_nop 0
    v_cvt_pk_bf16_f32 v148, v148, v149
    v_cvt_pk_bf16_f32 v149, v150, v151
    v_cvt_pk_bf16_f32 v150, v172, v173
    v_cvt_pk_bf16_f32 v151, v174, v175
    v_pk_fma_f32 v[196:197], v[196:197], s[66:67], v[234:235] neg_lo:[0,0,1] neg_hi:[0,0,1]
    v_pk_fma_f32 v[198:199], v[198:199], s[66:67], v[234:235] neg_lo:[0,0,1] neg_hi:[0,0,1]
    v_pk_fma_f32 v[220:221], v[220:221], s[66:67], v[234:235] neg_lo:[0,0,1] neg_hi:[0,0,1]
    v_pk_fma_f32 v[222:223], v[222:223], s[66:67], v[234:235] neg_lo:[0,0,1] neg_hi:[0,0,1]
    v_mfma_f32_16x16x32_bf16 a[132:135], a[96:99], v[148:151], a[132:135]
    v_exp_f32 v196, v196
    v_exp_f32 v197, v197
    v_exp_f32 v198, v198
    v_exp_f32 v199, v199
    v_exp_f32 v220, v220
    v_exp_f32 v221, v221
    v_exp_f32 v222, v222
    v_exp_f32 v223, v223
    s_nop 0
    v_cvt_pk_bf16_f32 v196, v196, v197
    v_cvt_pk_bf16_f32 v197, v198, v199
    v_cvt_pk_bf16_f32 v198, v220, v221
    v_cvt_pk_bf16_f32 v199, v222, v223
    s_nop 1
    v_mfma_f32_16x16x32_bf16 a[132:135], a[96:99], v[196:199], a[132:135]
    s_nop 7
    v_accvgpr_read_b32 v236, a112
    v_accvgpr_read_b32 v237, a116
    v_accvgpr_read_b32 v238, a120
    v_accvgpr_read_b32 v239, a124
    v_accvgpr_read_b32 v240, a128
    v_accvgpr_read_b32 v241, a132
    ds_write_b32 v27, v236 offset:6144
    ds_write_b32 v27, v237 offset:6400
    ds_write_b32 v27, v238 offset:6656
    ds_write_b32 v27, v239 offset:6912
    ds_write_b32 v27, v240 offset:7168
    ds_write_b32 v27, v241 offset:7424
    s_waitcnt lgkmcnt(0)
    s_barrier
    ds_read_b128 v[236:239], v28 offset:6144
    ds_read_b128 v[240:243], v28 offset:6400
    ds_read_b128 v[244:247], v28 offset:6656
    ds_read_b128 v[248:251], v28 offset:6912
    ds_read_b128 v[252:255], v28 offset:7168
    ds_read_b128 v[12:15], v28 offset:7424
    s_waitcnt lgkmcnt(0)
    v_add_f32 v236, v236, v237
    v_add_f32 v238, v238, v239
    v_add_f32 v236, v236, v238
    v_rcp_f32 v224, v236
    v_rcp_f32 v225, v236
    v_add_f32 v240, v240, v241
    v_add_f32 v242, v242, v243
    v_add_f32 v240, v240, v242
    v_rcp_f32 v226, v240
    v_rcp_f32 v227, v240
    v_add_f32 v244, v244, v245
    v_add_f32 v246, v246, v247
    v_add_f32 v244, v244, v246
    v_rcp_f32 v228, v244
    v_rcp_f32 v229, v244
    v_add_f32 v248, v248, v249
    v_add_f32 v250, v250, v251
    v_add_f32 v248, v248, v250
    v_rcp_f32 v230, v248
    v_rcp_f32 v231, v248
    v_add_f32 v252, v252, v253
    v_add_f32 v254, v254, v255
    v_add_f32 v252, v252, v254
    v_rcp_f32 v232, v252
    v_rcp_f32 v233, v252
    v_add_f32 v12, v12, v13
    v_add_f32 v14, v14, v15
    v_add_f32 v12, v12, v14
    v_rcp_f32 v234, v12
    v_rcp_f32 v235, v12
    s_waitcnt vmcnt(19)
    ds_read_b64_tr_b16 a[192:193], v21 offset:0
    ds_read_b64_tr_b16 a[194:195], v21 offset:2048
    ds_read_b64_tr_b16 a[196:197], v22 offset:0
    ds_read_b64_tr_b16 a[198:199], v22 offset:2048
    ds_read_b64_tr_b16 a[200:201], v23 offset:0
    ds_read_b64_tr_b16 a[202:203], v23 offset:2048
    ds_read_b64_tr_b16 a[204:205], v24 offset:0
    ds_read_b64_tr_b16 a[206:207], v24 offset:2048
    s_waitcnt vmcnt(15)
    ds_read_b64_tr_b16 a[208:209], v21 offset:4096
    ds_read_b64_tr_b16 a[210:211], v21 offset:6144
    ds_read_b64_tr_b16 a[212:213], v22 offset:4096
    ds_read_b64_tr_b16 a[214:215], v22 offset:6144
    ds_read_b64_tr_b16 a[216:217], v23 offset:4096
    ds_read_b64_tr_b16 a[218:219], v23 offset:6144
    ds_read_b64_tr_b16 a[220:221], v24 offset:4096
    ds_read_b64_tr_b16 a[222:223], v24 offset:6144
    s_waitcnt lgkmcnt(8)
    v_mfma_f32_16x16x32_bf16 v[56:59], a[192:195], v[32:35], 0
    v_mfma_f32_16x16x32_bf16 v[60:63], a[192:195], v[36:39], 0
    v_mfma_f32_16x16x32_bf16 v[64:67], a[192:195], v[40:43], 0
    v_mfma_f32_16x16x32_bf16 v[68:71], a[192:195], v[44:47], 0
    s_add_u32 m0, s57, 22528
    s_add_u32 s55, s56, 12288
    buffer_load_dwordx4 v20, s[16:19], s55 offen nt lds
    v_mfma_f32_16x16x32_bf16 v[72:75], a[192:195], v[48:51], 0
    v_mfma_f32_16x16x32_bf16 v[76:79], a[192:195], v[52:55], 0
    v_mfma_f32_16x16x32_bf16 v[104:107], a[196:199], v[32:35], 0
    v_mfma_f32_16x16x32_bf16 v[108:111], a[196:199], v[36:39], 0
    v_mfma_f32_16x16x32_bf16 v[112:115], a[196:199], v[40:43], 0
    v_mfma_f32_16x16x32_bf16 v[116:119], a[196:199], v[44:47], 0
    s_add_u32 m0, s57, 23552
    s_add_u32 s55, s56, 14336
    buffer_load_dwordx4 v20, s[16:19], s55 offen nt lds
    v_mfma_f32_16x16x32_bf16 v[120:123], a[196:199], v[48:51], 0
    v_mfma_f32_16x16x32_bf16 v[124:127], a[196:199], v[52:55], 0
    v_mfma_f32_16x16x32_bf16 v[152:155], a[200:203], v[32:35], 0
    v_mfma_f32_16x16x32_bf16 v[156:159], a[200:203], v[36:39], 0
    v_mfma_f32_16x16x32_bf16 v[160:163], a[200:203], v[40:43], 0
    v_mfma_f32_16x16x32_bf16 v[164:167], a[200:203], v[44:47], 0
    s_add_u32 m0, s57, 24576
    s_add_u32 s55, s56, 16384
    buffer_load_dwordx4 v20, s[16:19], s55 offen nt lds
    v_mfma_f32_16x16x32_bf16 v[168:171], a[200:203], v[48:51], 0
    v_mfma_f32_16x16x32_bf16 v[172:175], a[200:203], v[52:55], 0
    v_mfma_f32_16x16x32_bf16 v[200:203], a[204:207], v[32:35], 0
    v_mfma_f32_16x16x32_bf16 v[204:207], a[204:207], v[36:39], 0
    v_mfma_f32_16x16x32_bf16 v[208:211], a[204:207], v[40:43], 0
    v_mfma_f32_16x16x32_bf16 v[212:215], a[204:207], v[44:47], 0
    s_add_u32 m0, s57, 25600
    s_add_u32 s55, s56, 18432
    buffer_load_dwordx4 v20, s[16:19], s55 offen nt lds
    v_mfma_f32_16x16x32_bf16 v[216:219], a[204:207], v[48:51], 0
    v_mfma_f32_16x16x32_bf16 v[220:223], a[204:207], v[52:55], 0
    s_waitcnt vmcnt(15)
    ds_read_b64_tr_b16 a[192:193], v21 offset:8192
    ds_read_b64_tr_b16 a[194:195], v21 offset:10240
    ds_read_b64_tr_b16 a[196:197], v22 offset:8192
    ds_read_b64_tr_b16 a[198:199], v22 offset:10240
    ds_read_b64_tr_b16 a[200:201], v23 offset:8192
    ds_read_b64_tr_b16 a[202:203], v23 offset:10240
    ds_read_b64_tr_b16 a[204:205], v24 offset:8192
    ds_read_b64_tr_b16 a[206:207], v24 offset:10240
    s_waitcnt lgkmcnt(8)
    v_mfma_f32_16x16x32_bf16 v[56:59], a[208:211], v[80:83], v[56:59]
    v_mfma_f32_16x16x32_bf16 v[60:63], a[208:211], v[84:87], v[60:63]
    v_mfma_f32_16x16x32_bf16 v[64:67], a[208:211], v[88:91], v[64:67]
    v_mfma_f32_16x16x32_bf16 v[68:71], a[208:211], v[92:95], v[68:71]
    s_add_u32 m0, s57, 26624
    s_add_u32 s55, s56, 20480
    buffer_load_dwordx4 v20, s[16:19], s55 offen nt lds
    v_mfma_f32_16x16x32_bf16 v[72:75], a[208:211], v[96:99], v[72:75]
    v_mfma_f32_16x16x32_bf16 v[76:79], a[208:211], v[100:103], v[76:79]
    v_mfma_f32_16x16x32_bf16 v[104:107], a[212:215], v[80:83], v[104:107]
    v_mfma_f32_16x16x32_bf16 v[108:111], a[212:215], v[84:87], v[108:111]
    v_mfma_f32_16x16x32_bf16 v[112:115], a[212:215], v[88:91], v[112:115]
    v_mfma_f32_16x16x32_bf16 v[116:119], a[212:215], v[92:95], v[116:119]
    s_add_u32 m0, s57, 27648
    s_add_u32 s55, s56, 22528
    buffer_load_dwordx4 v20, s[16:19], s55 offen nt lds
    v_mfma_f32_16x16x32_bf16 v[120:123], a[212:215], v[96:99], v[120:123]
    v_mfma_f32_16x16x32_bf16 v[124:127], a[212:215], v[100:103], v[124:127]
    v_mfma_f32_16x16x32_bf16 v[152:155], a[216:219], v[80:83], v[152:155]
    v_mfma_f32_16x16x32_bf16 v[156:159], a[216:219], v[84:87], v[156:159]
    v_mfma_f32_16x16x32_bf16 v[160:163], a[216:219], v[88:91], v[160:163]
    v_mfma_f32_16x16x32_bf16 v[164:167], a[216:219], v[92:95], v[164:167]
    s_add_u32 m0, s57, 28672
    s_add_u32 s55, s56, 24576
    buffer_load_dwordx4 v20, s[16:19], s55 offen nt lds
    v_mfma_f32_16x16x32_bf16 v[168:171], a[216:219], v[96:99], v[168:171]
    v_mfma_f32_16x16x32_bf16 v[172:175], a[216:219], v[100:103], v[172:175]
    v_mfma_f32_16x16x32_bf16 v[200:203], a[220:223], v[80:83], v[200:203]
    v_mfma_f32_16x16x32_bf16 v[204:207], a[220:223], v[84:87], v[204:207]
    v_mfma_f32_16x16x32_bf16 v[208:211], a[220:223], v[88:91], v[208:211]
    v_mfma_f32_16x16x32_bf16 v[212:215], a[220:223], v[92:95], v[212:215]
    s_add_u32 m0, s57, 29696
    s_add_u32 s55, s56, 26624
    buffer_load_dwordx4 v20, s[16:19], s55 offen nt lds
    v_mfma_f32_16x16x32_bf16 v[216:219], a[220:223], v[96:99], v[216:219]
    v_mfma_f32_16x16x32_bf16 v[220:223], a[220:223], v[100:103], v[220:223]
    s_waitcnt vmcnt(15)
    ds_read_b64_tr_b16 a[208:209], v21 offset:12288
    ds_read_b64_tr_b16 a[210:211], v21 offset:14336
    ds_read_b64_tr_b16 a[212:213], v22 offset:12288
    ds_read_b64_tr_b16 a[214:215], v22 offset:14336
    ds_read_b64_tr_b16 a[216:217], v23 offset:12288
    ds_read_b64_tr_b16 a[218:219], v23 offset:14336
    ds_read_b64_tr_b16 a[220:221], v24 offset:12288
    ds_read_b64_tr_b16 a[222:223], v24 offset:14336
    s_waitcnt lgkmcnt(8)
    v_mfma_f32_16x16x32_bf16 v[56:59], a[192:195], v[128:131], v[56:59]
    v_mfma_f32_16x16x32_bf16 v[60:63], a[192:195], v[132:135], v[60:63]
    v_mfma_f32_16x16x32_bf16 v[64:67], a[192:195], v[136:139], v[64:67]
    v_mfma_f32_16x16x32_bf16 v[68:71], a[192:195], v[140:143], v[68:71]
    s_add_u32 m0, s57, 30720
    s_add_u32 s55, s56, 28672
    buffer_load_dwordx4 v20, s[16:19], s55 offen nt lds
    v_mfma_f32_16x16x32_bf16 v[72:75], a[192:195], v[144:147], v[72:75]
    v_mfma_f32_16x16x32_bf16 v[76:79], a[192:195], v[148:151], v[76:79]
    v_mfma_f32_16x16x32_bf16 v[104:107], a[196:199], v[128:131], v[104:107]
    v_mfma_f32_16x16x32_bf16 v[108:111], a[196:199], v[132:135], v[108:111]
    v_mfma_f32_16x16x32_bf16 v[112:115], a[196:199], v[136:139], v[112:115]
    v_mfma_f32_16x16x32_bf16 v[116:119], a[196:199], v[140:143], v[116:119]
    s_add_u32 m0, s57, 31744
    s_add_u32 s55, s56, 30720
    buffer_load_dwordx4 v20, s[16:19], s55 offen nt lds
    v_mfma_f32_16x16x32_bf16 v[120:123], a[196:199], v[144:147], v[120:123]
    v_mfma_f32_16x16x32_bf16 v[124:127], a[196:199], v[148:151], v[124:127]
    v_mfma_f32_16x16x32_bf16 v[152:155], a[200:203], v[128:131], v[152:155]
    v_mfma_f32_16x16x32_bf16 v[156:159], a[200:203], v[132:135], v[156:159]
    v_mfma_f32_16x16x32_bf16 v[160:163], a[200:203], v[136:139], v[160:163]
    v_mfma_f32_16x16x32_bf16 v[164:167], a[200:203], v[140:143], v[164:167]
    v_mfma_f32_16x16x32_bf16 v[168:171], a[200:203], v[144:147], v[168:171]
    v_mfma_f32_16x16x32_bf16 v[172:175], a[200:203], v[148:151], v[172:175]
    v_mfma_f32_16x16x32_bf16 v[200:203], a[204:207], v[128:131], v[200:203]
    v_mfma_f32_16x16x32_bf16 v[204:207], a[204:207], v[132:135], v[204:207]
    v_mfma_f32_16x16x32_bf16 v[208:211], a[204:207], v[136:139], v[208:211]
    v_mfma_f32_16x16x32_bf16 v[212:215], a[204:207], v[140:143], v[212:215]
    v_mfma_f32_16x16x32_bf16 v[216:219], a[204:207], v[144:147], v[216:219]
    v_mfma_f32_16x16x32_bf16 v[220:223], a[204:207], v[148:151], v[220:223]
    s_waitcnt lgkmcnt(0)
    v_mfma_f32_16x16x32_bf16 v[56:59], a[208:211], v[176:179], v[56:59]
    v_mfma_f32_16x16x32_bf16 v[60:63], a[208:211], v[180:183], v[60:63]
    v_mfma_f32_16x16x32_bf16 v[64:67], a[208:211], v[184:187], v[64:67]
    v_mfma_f32_16x16x32_bf16 v[68:71], a[208:211], v[188:191], v[68:71]
    v_mfma_f32_16x16x32_bf16 v[72:75], a[208:211], v[192:195], v[72:75]
    v_mfma_f32_16x16x32_bf16 v[76:79], a[208:211], v[196:199], v[76:79]
    v_mfma_f32_16x16x32_bf16 v[104:107], a[212:215], v[176:179], v[104:107]
    v_mfma_f32_16x16x32_bf16 v[108:111], a[212:215], v[180:183], v[108:111]
    v_mfma_f32_16x16x32_bf16 v[112:115], a[212:215], v[184:187], v[112:115]
    v_mfma_f32_16x16x32_bf16 v[116:119], a[212:215], v[188:191], v[116:119]
    v_mfma_f32_16x16x32_bf16 v[120:123], a[212:215], v[192:195], v[120:123]
    v_mfma_f32_16x16x32_bf16 v[124:127], a[212:215], v[196:199], v[124:127]
    v_mfma_f32_16x16x32_bf16 v[152:155], a[216:219], v[176:179], v[152:155]
    v_mfma_f32_16x16x32_bf16 v[156:159], a[216:219], v[180:183], v[156:159]
    v_mfma_f32_16x16x32_bf16 v[160:163], a[216:219], v[184:187], v[160:163]
    v_mfma_f32_16x16x32_bf16 v[164:167], a[216:219], v[188:191], v[164:167]
    v_mfma_f32_16x16x32_bf16 v[168:171], a[216:219], v[192:195], v[168:171]
    v_mfma_f32_16x16x32_bf16 v[172:175], a[216:219], v[196:199], v[172:175]
    v_mfma_f32_16x16x32_bf16 v[200:203], a[220:223], v[176:179], v[200:203]
    v_mfma_f32_16x16x32_bf16 v[204:207], a[220:223], v[180:183], v[204:207]
    v_mfma_f32_16x16x32_bf16 v[208:211], a[220:223], v[184:187], v[208:211]
    v_mfma_f32_16x16x32_bf16 v[212:215], a[220:223], v[188:191], v[212:215]
    v_mfma_f32_16x16x32_bf16 v[216:219], a[220:223], v[192:195], v[216:219]
    v_mfma_f32_16x16x32_bf16 v[220:223], a[220:223], v[196:199], v[220:223]
    s_nop 3
    ds_write_b128 v25, v[56:59] offset:0
    ds_write_b128 v25, v[60:63] offset:1024
    ds_write_b128 v25, v[64:67] offset:2048
    ds_write_b128 v25, v[68:71] offset:3072
    ds_write_b128 v25, v[72:75] offset:4096
    ds_write_b128 v25, v[76:79] offset:5120
    ds_write_b128 v25, v[104:107] offset:6144
    ds_write_b128 v25, v[108:111] offset:7168
    ds_write_b128 v25, v[112:115] offset:8192
    ds_write_b128 v25, v[116:119] offset:9216
    ds_write_b128 v25, v[120:123] offset:10240
    ds_write_b128 v25, v[124:127] offset:11264
    ds_write_b128 v25, v[152:155] offset:12288
    ds_write_b128 v25, v[156:159] offset:13312
    ds_write_b128 v25, v[160:163] offset:14336
    ds_write_b128 v25, v[164:167] offset:15360
    ds_write_b128 v26, v[168:171] offset:0
    ds_write_b128 v26, v[172:175] offset:1024
    ds_write_b128 v26, v[200:203] offset:2048
    ds_write_b128 v26, v[204:207] offset:3072
    ds_write_b128 v26, v[208:211] offset:4096
    ds_write_b128 v26, v[212:215] offset:5120
    ds_write_b128 v26, v[216:219] offset:6144
    ds_write_b128 v26, v[220:223] offset:7168
    s_waitcnt lgkmcnt(0)
    s_barrier
    ds_read_b128 v[152:155], v3 offset:0
    ds_read_b128 v[56:59], v4 offset:12288
    ds_read_b128 v[156:159], v3 offset:1024
    ds_read_b128 v[60:63], v4 offset:13312
    ds_read_b128 v[160:163], v3 offset:2048
    ds_read_b128 v[64:67], v4 offset:14336
    ds_read_b128 v[164:167], v3 offset:3072
    ds_read_b128 v[68:71], v4 offset:15360
    ds_read_b128 v[168:171], v3 offset:4096
    ds_read_b128 v[72:75], v5 offset:0
    ds_read_b128 v[172:175], v3 offset:5120
    ds_read_b128 v[76:79], v5 offset:1024
    ds_read_b128 v[200:203], v3 offset:6144
    ds_read_b128 v[104:107], v5 offset:2048
    ds_read_b128 v[204:207], v3 offset:7168
    ds_read_b128 v[108:111], v5 offset:3072
    ds_read_b128 v[208:211], v3 offset:8192
    ds_read_b128 v[112:115], v5 offset:4096
    ds_read_b128 v[212:215], v3 offset:9216
    ds_read_b128 v[116:119], v5 offset:5120
    ds_read_b128 v[216:219], v3 offset:10240
    ds_read_b128 v[120:123], v5 offset:6144
    ds_read_b128 v[220:223], v3 offset:11264
    ds_read_b128 v[124:127], v5 offset:7168
    s_waitcnt lgkmcnt(0)
    v_pk_add_f32 v[152:153], v[152:153], v[56:57]
    v_pk_add_f32 v[154:155], v[154:155], v[58:59]
    v_pk_add_f32 v[156:157], v[156:157], v[60:61]
    v_pk_add_f32 v[158:159], v[158:159], v[62:63]
    v_pk_add_f32 v[160:161], v[160:161], v[64:65]
    v_pk_add_f32 v[162:163], v[162:163], v[66:67]
    v_pk_add_f32 v[164:165], v[164:165], v[68:69]
    v_pk_add_f32 v[166:167], v[166:167], v[70:71]
    v_pk_add_f32 v[168:169], v[168:169], v[72:73]
    v_pk_add_f32 v[170:171], v[170:171], v[74:75]
    v_pk_add_f32 v[172:173], v[172:173], v[76:77]
    v_pk_add_f32 v[174:175], v[174:175], v[78:79]
    v_pk_add_f32 v[200:201], v[200:201], v[104:105]
    v_pk_add_f32 v[202:203], v[202:203], v[106:107]
    v_pk_add_f32 v[204:205], v[204:205], v[108:109]
    v_pk_add_f32 v[206:207], v[206:207], v[110:111]
    v_pk_add_f32 v[208:209], v[208:209], v[112:113]
    v_pk_add_f32 v[210:211], v[210:211], v[114:115]
    v_pk_add_f32 v[212:213], v[212:213], v[116:117]
    v_pk_add_f32 v[214:215], v[214:215], v[118:119]
    v_pk_add_f32 v[216:217], v[216:217], v[120:121]
    v_pk_add_f32 v[218:219], v[218:219], v[122:123]
    v_pk_add_f32 v[220:221], v[220:221], v[124:125]
    v_pk_add_f32 v[222:223], v[222:223], v[126:127]
    s_nop 1
    s_waitcnt vmcnt(13)
    ds_read_b64_tr_b16 a[192:193], v21 offset:16384
    ds_read_b64_tr_b16 a[194:195], v21 offset:18432
    ds_read_b64_tr_b16 a[196:197], v22 offset:16384
    ds_read_b64_tr_b16 a[198:199], v22 offset:18432
    ds_read_b64_tr_b16 a[200:201], v23 offset:16384
    ds_read_b64_tr_b16 a[202:203], v23 offset:18432
    ds_read_b64_tr_b16 a[204:205], v24 offset:16384
    ds_read_b64_tr_b16 a[206:207], v24 offset:18432
    s_waitcnt lgkmcnt(4)
    v_mfma_f32_16x16x32_bf16 v[56:59], a[192:195], v[32:35], 0
    v_mfma_f32_16x16x32_bf16 v[60:63], a[192:195], v[36:39], 0
    v_mfma_f32_16x16x32_bf16 v[64:67], a[192:195], v[40:43], 0
    v_mfma_f32_16x16x32_bf16 v[68:71], a[192:195], v[44:47], 0
    v_mfma_f32_16x16x32_bf16 v[72:75], a[192:195], v[48:51], 0
    v_mfma_f32_16x16x32_bf16 v[76:79], a[192:195], v[52:55], 0
    v_mfma_f32_16x16x32_bf16 v[104:107], a[196:199], v[32:35], 0
    v_mfma_f32_16x16x32_bf16 v[108:111], a[196:199], v[36:39], 0
    v_mfma_f32_16x16x32_bf16 v[112:115], a[196:199], v[40:43], 0
    v_mfma_f32_16x16x32_bf16 v[116:119], a[196:199], v[44:47], 0
    v_mfma_f32_16x16x32_bf16 v[120:123], a[196:199], v[48:51], 0
    v_mfma_f32_16x16x32_bf16 v[124:127], a[196:199], v[52:55], 0
    s_waitcnt lgkmcnt(0)
    v_mfma_f32_16x16x32_bf16 v[152:155], a[200:203], v[32:35], v[152:155]
    v_mfma_f32_16x16x32_bf16 v[156:159], a[200:203], v[36:39], v[156:159]
    v_mfma_f32_16x16x32_bf16 v[160:163], a[200:203], v[40:43], v[160:163]
    v_mfma_f32_16x16x32_bf16 v[164:167], a[200:203], v[44:47], v[164:167]
    v_mfma_f32_16x16x32_bf16 v[168:171], a[200:203], v[48:51], v[168:171]
    v_mfma_f32_16x16x32_bf16 v[172:175], a[200:203], v[52:55], v[172:175]
    v_mfma_f32_16x16x32_bf16 v[200:203], a[204:207], v[32:35], v[200:203]
    v_mfma_f32_16x16x32_bf16 v[204:207], a[204:207], v[36:39], v[204:207]
    v_mfma_f32_16x16x32_bf16 v[208:211], a[204:207], v[40:43], v[208:211]
    v_mfma_f32_16x16x32_bf16 v[212:215], a[204:207], v[44:47], v[212:215]
    v_mfma_f32_16x16x32_bf16 v[216:219], a[204:207], v[48:51], v[216:219]
    v_mfma_f32_16x16x32_bf16 v[220:223], a[204:207], v[52:55], v[220:223]
    s_waitcnt vmcnt(8)
    ds_read_b64_tr_b16 a[208:209], v21 offset:20480
    ds_read_b64_tr_b16 a[210:211], v21 offset:22528
    ds_read_b64_tr_b16 a[212:213], v22 offset:20480
    ds_read_b64_tr_b16 a[214:215], v22 offset:22528
    ds_read_b64_tr_b16 a[216:217], v23 offset:20480
    ds_read_b64_tr_b16 a[218:219], v23 offset:22528
    ds_read_b64_tr_b16 a[220:221], v24 offset:20480
    ds_read_b64_tr_b16 a[222:223], v24 offset:22528
    v_cmp_ne_u32 vcc, s6, v7
    s_nop 4
    s_cbranch_vccz L_pollw_done
    s_mov_b32 s43, s63
    v_mov_b32 v31, v19
    s_mov_b32 s55, 0
L_pollw:
    buffer_load_dword v30, v31, s[32:35], s43 offen sc1
    s_waitcnt vmcnt(0)
    v_cmp_ne_u32 vcc, s6, v30
    s_add_u32 s55, s55, 1
    s_nop 3
    s_cbranch_vccz L_pollw_done
    s_sleep 2
    s_cmp_lt_u32 s55, 200000
    s_cbranch_scc1 L_pollw
L_pollw_done:
    s_waitcnt lgkmcnt(4)
    v_mfma_f32_16x16x32_bf16 v[56:59], a[208:211], v[80:83], v[56:59]
    v_mfma_f32_16x16x32_bf16 v[60:63], a[208:211], v[84:87], v[60:63]
    s_add_u32 s65, s4, 0
    s_and_b32 s65, s65, 15
    s_lshl_b32 s65, s65, 12
    s_add_u32 s65, s65, s58
    buffer_load_dwordx4 a[224:227], v8, s[32:35], s65 offen offset:0 sc1
    v_mfma_f32_16x16x32_bf16 v[64:67], a[208:211], v[88:91], v[64:67]
    v_mfma_f32_16x16x32_bf16 v[68:71], a[208:211], v[92:95], v[68:71]
    v_mfma_f32_16x16x32_bf16 v[72:75], a[208:211], v[96:99], v[72:75]
    buffer_load_dwordx4 a[228:231], v8, s[32:35], s65 offen offset:1024 sc1
    v_mfma_f32_16x16x32_bf16 v[76:79], a[208:211], v[100:103], v[76:79]
    v_mfma_f32_16x16x32_bf16 v[104:107], a[212:215], v[80:83], v[104:107]
    v_mfma_f32_16x16x32_bf16 v[108:111], a[212:215], v[84:87], v[108:111]
    buffer_load_dwordx4 a[232:235], v8, s[32:35], s65 offen offset:2048 sc1
    v_mfma_f32_16x16x32_bf16 v[112:115], a[212:215], v[88:91], v[112:115]
    v_mfma_f32_16x16x32_bf16 v[116:119], a[212:215], v[92:95], v[116:119]
    v_mfma_f32_16x16x32_bf16 v[120:123], a[212:215], v[96:99], v[120:123]
    buffer_load_dwordx4 a[236:239], v8, s[32:35], s65 offen offset:3072 sc1
    v_mfma_f32_16x16x32_bf16 v[124:127], a[212:215], v[100:103], v[124:127]
    s_waitcnt lgkmcnt(0)
    v_mfma_f32_16x16x32_bf16 v[152:155], a[216:219], v[80:83], v[152:155]
    v_mfma_f32_16x16x32_bf16 v[156:159], a[216:219], v[84:87], v[156:159]
    s_add_u32 s65, s4, 1
    s_and_b32 s65, s65, 15
    s_lshl_b32 s65, s65, 12
    s_add_u32 s65, s65, s58
    buffer_load_dwordx4 a[240:243], v8, s[32:35], s65 offen offset:0 sc1
    v_mfma_f32_16x16x32_bf16 v[160:163], a[216:219], v[88:91], v[160:163]
    v_mfma_f32_16x16x32_bf16 v[164:167], a[216:219], v[92:95], v[164:167]
    v_mfma_f32_16x16x32_bf16 v[168:171], a[216:219], v[96:99], v[168:171]
    buffer_load_dwordx4 a[244:247], v8, s[32:35], s65 offen offset:1024 sc1
    v_mfma_f32_16x16x32_bf16 v[172:175], a[216:219], v[100:103], v[172:175]
    v_mfma_f32_16x16x32_bf16 v[200:203], a[220:223], v[80:83], v[200:203]
    v_mfma_f32_16x16x32_bf16 v[204:207], a[220:223], v[84:87], v[204:207]
    buffer_load_dwordx4 a[248:251], v8, s[32:35], s65 offen offset:2048 sc1
    v_mfma_f32_16x16x32_bf16 v[208:211], a[220:223], v[88:91], v[208:211]
    v_mfma_f32_16x16x32_bf16 v[212:215], a[220:223], v[92:95], v[212:215]
    v_mfma_f32_16x16x32_bf16 v[216:219], a[220:223], v[96:99], v[216:219]
    buffer_load_dwordx4 a[252:255], v8, s[32:35], s65 offen offset:3072 sc1
    v_mfma_f32_16x16x32_bf16 v[220:223], a[220:223], v[100:103], v[220:223]
    s_waitcnt vmcnt(12)
    ds_read_b64_tr_b16 a[192:193], v21 offset:24576
    ds_read_b64_tr_b16 a[194:195], v21 offset:26624
    ds_read_b64_tr_b16 a[196:197], v22 offset:24576
    ds_read_b64_tr_b16 a[198:199], v22 offset:26624
    ds_read_b64_tr_b16 a[200:201], v23 offset:24576
    ds_read_b64_tr_b16 a[202:203], v23 offset:26624
    ds_read_b64_tr_b16 a[204:205], v24 offset:24576
    ds_read_b64_tr_b16 a[206:207], v24 offset:26624
    s_waitcnt lgkmcnt(4)
    v_mfma_f32_16x16x32_bf16 v[56:59], a[192:195], v[128:131], v[56:59]
    v_mfma_f32_16x16x32_bf16 v[60:63], a[192:195], v[132:135], v[60:63]
    s_add_u32 s65, s4, 2
    s_and_b32 s65, s65, 15
    s_lshl_b32 s65, s65, 12
    s_add_u32 s65, s65, s58
    buffer_load_dwordx4 a[0:3], v8, s[32:35], s65 offen offset:0 sc1
    v_mfma_f32_16x16x32_bf16 v[64:67], a[192:195], v[136:139], v[64:67]
    v_mfma_f32_16x16x32_bf16 v[68:71], a[192:195], v[140:143], v[68:71]
    v_mfma_f32_16x16x32_bf16 v[72:75], a[192:195], v[144:147], v[72:75]
    buffer_load_dwordx4 a[4:7], v8, s[32:35], s65 offen offset:1024 sc1
    v_mfma_f32_16x16x32_bf16 v[76:79], a[192:195], v[148:151], v[76:79]
    v_mfma_f32_16x16x32_bf16 v[104:107], a[196:199], v[128:131], v[104:107]
    v_mfma_f32_16x16x32_bf16 v[108:111], a[196:199], v[132:135], v[108:111]
    buffer_load_dwordx4 a[8:11], v8, s[32:35], s65 offen offset:2048 sc1
    v_mfma_f32_16x16x32_bf16 v[112:115], a[196:199], v[136:139], v[112:115]
    v_mfma_f32_16x16x32_bf16 v[116:119], a[196:199], v[140:143], v[116:119]
    v_mfma_f32_16x16x32_bf16 v[120:123], a[196:199], v[144:147], v[120:123]
    buffer_load_dwordx4 a[12:15], v8, s[32:35], s65 offen offset:3072 sc1
    v_mfma_f32_16x16x32_bf16 v[124:127], a[196:199], v[148:151], v[124:127]
    s_waitcnt lgkmcnt(0)
    v_mfma_f32_16x16x32_bf16 v[152:155], a[200:203], v[128:131], v[152:155]
    v_mfma_f32_16x16x32_bf16 v[156:159], a[200:203], v[132:135], v[156:159]
    s_add_u32 s65, s4, 3
    s_and_b32 s65, s65, 15
    s_lshl_b32 s65, s65, 12
    s_add_u32 s65, s65, s58
    buffer_load_dwordx4 a[16:19], v8, s[32:35], s65 offen offset:0 sc1
    v_mfma_f32_16x16x32_bf16 v[160:163], a[200:203], v[136:139], v[160:163]
    v_mfma_f32_16x16x32_bf16 v[164:167], a[200:203], v[140:143], v[164:167]
    v_mfma_f32_16x16x32_bf16 v[168:171], a[200:203], v[144:147], v[168:171]
    buffer_load_dwordx4 a[20:23], v8, s[32:35], s65 offen offset:1024 sc1
    v_mfma_f32_16x16x32_bf16 v[172:175], a[200:203], v[148:151], v[172:175]
    v_mfma_f32_16x16x32_bf16 v[200:203], a[204:207], v[128:131], v[200:203]
    v_mfma_f32_16x16x32_bf16 v[204:207], a[204:207], v[132:135], v[204:207]
    buffer_load_dwordx4 a[24:27], v8, s[32:35], s65 offen offset:2048 sc1
    v_mfma_f32_16x16x32_bf16 v[208:211], a[204:207], v[136:139], v[208:211]
    v_mfma_f32_16x16x32_bf16 v[212:215], a[204:207], v[140:143], v[212:215]
    v_mfma_f32_16x16x32_bf16 v[216:219], a[204:207], v[144:147], v[216:219]
    buffer_load_dwordx4 a[28:31], v8, s[32:35], s65 offen offset:3072 sc1
    v_mfma_f32_16x16x32_bf16 v[220:223], a[204:207], v[148:151], v[220:223]
    s_waitcnt vmcnt(16)
    ds_read_b64_tr_b16 a[208:209], v21 offset:28672
    ds_read_b64_tr_b16 a[210:211], v21 offset:30720
    ds_read_b64_tr_b16 a[212:213], v22 offset:28672
    ds_read_b64_tr_b16 a[214:215], v22 offset:30720
    ds_read_b64_tr_b16 a[216:217], v23 offset:28672
    ds_read_b64_tr_b16 a[218:219], v23 offset:30720
    ds_read_b64_tr_b16 a[220:221], v24 offset:28672
    ds_read_b64_tr_b16 a[222:223], v24 offset:30720
    s_waitcnt lgkmcnt(4)
    v_mfma_f32_16x16x32_bf16 v[56:59], a[208:211], v[176:179], v[56:59]
    v_mfma_f32_16x16x32_bf16 v[60:63], a[208:211], v[180:183], v[60:63]
    s_add_u32 s65, s4, 4
    s_and_b32 s65, s65, 15
    s_lshl_b32 s65, s65, 12
    s_add_u32 s65, s65, s58
    buffer_load_dwordx4 a[32:35], v8, s[32:35], s65 offen offset:0 sc1
    v_mfma_f32_16x16x32_bf16 v[64:67], a[208:211], v[184:187], v[64:67]
    v_mfma_f32_16x16x32_bf16 v[68:71], a[208:211], v[188:191], v[68:71]
    v_mfma_f32_16x16x32_bf16 v[72:75], a[208:211], v[192:195], v[72:75]
    buffer_load_dwordx4 a[36:39], v8, s[32:35], s65 offen offset:1024 sc1
    v_mfma_f32_16x16x32_bf16 v[76:79], a[208:211], v[196:199], v[76:79]
    v_mfma_f32_16x16x32_bf16 v[104:107], a[212:215], v[176:179], v[104:107]
    v_mfma_f32_16x16x32_bf16 v[108:111], a[212:215], v[180:183], v[108:111]
    buffer_load_dwordx4 a[40:43], v8, s[32:35], s65 offen offset:2048 sc1
    v_mfma_f32_16x16x32_bf16 v[112:115], a[212:215], v[184:187], v[112:115]
    v_mfma_f32_16x16x32_bf16 v[116:119], a[212:215], v[188:191], v[116:119]
    v_mfma_f32_16x16x32_bf16 v[120:123], a[212:215], v[192:195], v[120:123]
    buffer_load_dwordx4 a[44:47], v8, s[32:35], s65 offen offset:3072 sc1
    v_mfma_f32_16x16x32_bf16 v[124:127], a[212:215], v[196:199], v[124:127]
    s_waitcnt lgkmcnt(0)
    v_mfma_f32_16x16x32_bf16 v[152:155], a[216:219], v[176:179], v[152:155]
    v_mfma_f32_16x16x32_bf16 v[156:159], a[216:219], v[180:183], v[156:159]
    v_mfma_f32_16x16x32_bf16 v[160:163], a[216:219], v[184:187], v[160:163]
    v_mfma_f32_16x16x32_bf16 v[164:167], a[216:219], v[188:191], v[164:167]
    ds_write_b128 v25, v[56:59] offset:16384
    v_mfma_f32_16x16x32_bf16 v[168:171], a[216:219], v[192:195], v[168:171]
    ds_write_b128 v25, v[60:63] offset:17408
    v_mfma_f32_16x16x32_bf16 v[172:175], a[216:219], v[196:199], v[172:175]
    ds_write_b128 v25, v[64:67] offset:18432
    v_mfma_f32_16x16x32_bf16 v[200:203], a[220:223], v[176:179], v[200:203]
    ds_write_b128 v25, v[68:71] offset:19456
    v_mfma_f32_16x16x32_bf16 v[204:207], a[220:223], v[180:183], v[204:207]
    ds_write_b128 v25, v[72:75] offset:20480
    v_mfma_f32_16x16x32_bf16 v[208:211], a[220:223], v[184:187], v[208:211]
    ds_write_b128 v25, v[76:79] offset:21504
    v_mfma_f32_16x16x32_bf16 v[212:215], a[220:223], v[188:191], v[212:215]
    ds_write_b128 v25, v[104:107] offset:22528
    v_mfma_f32_16x16x32_bf16 v[216:219], a[220:223], v[192:195], v[216:219]
    ds_write_b128 v25, v[108:111] offset:23552
    v_mfma_f32_16x16x32_bf16 v[220:223], a[220:223], v[196:199], v[220:223]
    ds_write_b128 v25, v[112:115] offset:24576
    ds_write_b128 v25, v[116:119] offset:25600
    ds_write_b128 v25, v[120:123] offset:26624
    ds_write_b128 v25, v[124:127] offset:27648
    s_waitcnt lgkmcnt(0)
    s_barrier
    ds_read_b128 v[56:59], v6 offset:16384
    ds_read_b128 v[60:63], v6 offset:17408
    ds_read_b128 v[64:67], v6 offset:18432
    ds_read_b128 v[68:71], v6 offset:19456
    ds_read_b128 v[72:75], v6 offset:20480
    ds_read_b128 v[76:79], v6 offset:21504
    ds_read_b128 v[104:107], v6 offset:22528
    ds_read_b128 v[108:111], v6 offset:23552
    ds_read_b128 v[112:115], v6 offset:24576
    ds_read_b128 v[116:119], v6 offset:25600
    ds_read_b128 v[120:123], v6 offset:26624
    ds_read_b128 v[124:127], v6 offset:27648
    s_waitcnt lgkmcnt(0)
    v_pk_add_f32 v[152:153], v[152:153], v[56:57]
    v_pk_add_f32 v[154:155], v[154:155], v[58:59]
    v_pk_add_f32 v[156:157], v[156:157], v[60:61]
    v_pk_add_f32 v[158:159], v[158:159], v[62:63]
    v_pk_add_f32 v[160:161], v[160:161], v[64:65]
    v_pk_add_f32 v[162:163], v[162:163], v[66:67]
    v_pk_add_f32 v[164:165], v[164:165], v[68:69]
    v_pk_add_f32 v[166:167], v[166:167], v[70:71]
    v_pk_add_f32 v[168:169], v[168:169], v[72:73]
    v_pk_add_f32 v[170:171], v[170:171], v[74:75]
    v_pk_add_f32 v[172:173], v[172:173], v[76:77]
    v_pk_add_f32 v[174:175], v[174:175], v[78:79]
    v_pk_add_f32 v[200:201], v[200:201], v[104:105]
    v_pk_add_f32 v[202:203], v[202:203], v[106:107]
    v_pk_add_f32 v[204:205], v[204:205], v[108:109]
    v_pk_add_f32 v[206:207], v[206:207], v[110:111]
    v_pk_add_f32 v[208:209], v[208:209], v[112:113]
    v_pk_add_f32 v[210:211], v[210:211], v[114:115]
    v_pk_add_f32 v[212:213], v[212:213], v[116:117]
    v_pk_add_f32 v[214:215], v[214:215], v[118:119]
    v_pk_add_f32 v[216:217], v[216:217], v[120:121]
    v_pk_add_f32 v[218:219], v[218:219], v[122:123]
    v_pk_add_f32 v[220:221], v[220:221], v[124:125]
    v_pk_add_f32 v[222:223], v[222:223], v[126:127]
    s_lshl_b32 s43, s41, 5
    s_add_u32 s43, s43, s42
    s_lshl_b32 s43, s43, 2
    s_add_u32 s43, s43, s40
    s_mul_i32 s43, s43, 6144
    v_pk_mul_f32 v[152:153], v[152:153], v[224:225]
    v_pk_mul_f32 v[154:155], v[154:155], v[224:225]
    v_pk_mul_f32 v[200:201], v[200:201], v[224:225]
    v_pk_mul_f32 v[202:203], v[202:203], v[224:225]
    v_cvt_pk_bf16_f32 v56, v152, v153
    v_cvt_pk_bf16_f32 v57, v154, v155
    v_cvt_pk_bf16_f32 v58, v200, v201
    v_cvt_pk_bf16_f32 v59, v202, v203
    buffer_store_dwordx4 v[56:59], v8, s[32:35], s43 offen offset:0 sc1
    v_pk_mul_f32 v[156:157], v[156:157], v[226:227]
    v_pk_mul_f32 v[158:159], v[158:159], v[226:227]
    v_pk_mul_f32 v[204:205], v[204:205], v[226:227]
    v_pk_mul_f32 v[206:207], v[206:207], v[226:227]
    v_cvt_pk_bf16_f32 v60, v156, v157
    v_cvt_pk_bf16_f32 v61, v158, v159
    v_cvt_pk_bf16_f32 v62, v204, v205
    v_cvt_pk_bf16_f32 v63, v206, v207
    buffer_store_dwordx4 v[60:63], v8, s[32:35], s43 offen offset:1024 sc1
    v_pk_mul_f32 v[160:161], v[160:161], v[228:229]
    v_pk_mul_f32 v[162:163], v[162:163], v[228:229]
    v_pk_mul_f32 v[208:209], v[208:209], v[228:229]
    v_pk_mul_f32 v[210:211], v[210:211], v[228:229]
    v_cvt_pk_bf16_f32 v64, v160, v161
    v_cvt_pk_bf16_f32 v65, v162, v163
    v_cvt_pk_bf16_f32 v66, v208, v209
    v_cvt_pk_bf16_f32 v67, v210, v211
    buffer_store_dwordx4 v[64:67], v8, s[32:35], s43 offen offset:2048 sc1
    v_pk_mul_f32 v[164:165], v[164:165], v[230:231]
    v_pk_mul_f32 v[166:167], v[166:167], v[230:231]
    v_pk_mul_f32 v[212:213], v[212:213], v[230:231]
    v_pk_mul_f32 v[214:215], v[214:215], v[230:231]
    v_cvt_pk_bf16_f32 v68, v164, v165
    v_cvt_pk_bf16_f32 v69, v166, v167
    v_cvt_pk_bf16_f32 v70, v212, v213
    v_cvt_pk_bf16_f32 v71, v214, v215
    buffer_store_dwordx4 v[68:71], v8, s[32:35], s43 offen offset:3072 sc1
    v_pk_mul_f32 v[168:169], v[168:169], v[232:233]
    v_pk_mul_f32 v[170:171], v[170:171], v[232:233]
    v_pk_mul_f32 v[216:217], v[216:217], v[232:233]
    v_pk_mul_f32 v[218:219], v[218:219], v[232:233]
    v_cvt_pk_bf16_f32 v72, v168, v169
    v_cvt_pk_bf16_f32 v73, v170, v171
    v_cvt_pk_bf16_f32 v74, v216, v217
    v_cvt_pk_bf16_f32 v75, v218, v219
    s_add_u32 s43, s43, 4096
    buffer_store_dwordx4 v[72:75], v8, s[32:35], s43 offen offset:0 sc1
    v_pk_mul_f32 v[172:173], v[172:173], v[234:235]
    v_pk_mul_f32 v[174:175], v[174:175], v[234:235]
    v_pk_mul_f32 v[220:221], v[220:221], v[234:235]
    v_pk_mul_f32 v[222:223], v[222:223], v[234:235]
    v_cvt_pk_bf16_f32 v76, v172, v173
    v_cvt_pk_bf16_f32 v77, v174, v175
    v_cvt_pk_bf16_f32 v78, v220, v221
    v_cvt_pk_bf16_f32 v79, v222, v223
    buffer_store_dwordx4 v[76:79], v8, s[32:35], s43 offen offset:1024 sc1
    s_add_u32 s65, s4, 5
    s_and_b32 s65, s65, 15
    s_lshl_b32 s65, s65, 12
    s_add_u32 s65, s65, s58
    buffer_load_dwordx4 a[48:51], v8, s[32:35], s65 offen offset:0 sc1
    buffer_load_dwordx4 a[52:55], v8, s[32:35], s65 offen offset:1024 sc1
    buffer_load_dwordx4 a[56:59], v8, s[32:35], s65 offen offset:2048 sc1
    buffer_load_dwordx4 a[60:63], v8, s[32:35], s65 offen offset:3072 sc1
    s_add_u32 s65, s4, 6
    s_and_b32 s65, s65, 15
    s_lshl_b32 s65, s65, 12
    s_add_u32 s65, s65, s58
    buffer_load_dwordx4 a[64:67], v8, s[32:35], s65 offen offset:0 sc1
    buffer_load_dwordx4 a[68:71], v8, s[32:35], s65 offen offset:1024 sc1
    buffer_load_dwordx4 a[72:75], v8, s[32:35], s65 offen offset:2048 sc1
    buffer_load_dwordx4 a[76:79], v8, s[32:35], s65 offen offset:3072 sc1
    s_add_u32 s65, s4, 7
    s_and_b32 s65, s65, 15
    s_lshl_b32 s65, s65, 12
    s_add_u32 s65, s65, s58
    buffer_load_dwordx4 a[80:83], v8, s[32:35], s65 offen offset:0 sc1
    buffer_load_dwordx4 a[84:87], v8, s[32:35], s65 offen offset:1024 sc1
    buffer_load_dwordx4 a[88:91], v8, s[32:35], s65 offen offset:2048 sc1
    buffer_load_dwordx4 a[92:95], v8, s[32:35], s65 offen offset:3072 sc1
    s_waitcnt vmcnt(12)
    s_barrier
    s_cmp_lg_u32 s40, 0
    s_cbranch_scc1 L_sig1
    s_lshr_b32 s43, s42, 4
    s_lshl_b32 s44, s41, 1
    s_add_u32 s43, s43, s44
    s_lshl_b32 s43, s43, 7
    s_and_b32 s44, s42, 15
    s_lshl_b32 s44, s44, 2
    s_add_u32 s43, s43, s44
    s_add_u32 s43, s43, 10485760
    v_mov_b32 v30, s6
    v_mov_b32 v31, 0
    s_mov_b64 exec, 1
    buffer_store_dword v30, v31, s[32:35], s43 offen sc1
    s_mov_b64 exec, -1
L_sig1:
    s_add_u32 s65, s4, 8
    s_and_b32 s65, s65, 15
    s_lshl_b32 s65, s65, 12
    s_add_u32 s65, s65, s58
    buffer_load_dwordx4 a[96:99], v8, s[32:35], s65 offen offset:0 sc1
    buffer_load_dwordx4 a[100:103], v8, s[32:35], s65 offen offset:1024 sc1
    buffer_load_dwordx4 a[104:107], v8, s[32:35], s65 offen offset:2048 sc1
    buffer_load_dwordx4 a[108:111], v8, s[32:35], s65 offen offset:3072 sc1
    s_add_u32 s65, s4, 9
    s_and_b32 s65, s65, 15
    s_lshl_b32 s65, s65, 12
    s_add_u32 s65, s65, s58
    buffer_load_dwordx4 a[112:115], v8, s[32:35], s65 offen offset:0 sc1
    buffer_load_dwordx4 a[116:119], v8, s[32:35], s65 offen offset:1024 sc1
    buffer_load_dwordx4 a[120:123], v8, s[32:35], s65 offen offset:2048 sc1
    buffer_load_dwordx4 a[124:127], v8, s[32:35], s65 offen offset:3072 sc1
    s_add_u32 s65, s4, 10
    s_and_b32 s65, s65, 15
    s_lshl_b32 s65, s65, 12
    s_add_u32 s65, s65, s58
    buffer_load_dwordx4 a[128:131], v8, s[32:35], s65 offen offset:0 sc1
    buffer_load_dwordx4 a[132:135], v8, s[32:35], s65 offen offset:1024 sc1
    buffer_load_dwordx4 a[136:139], v8, s[32:35], s65 offen offset:2048 sc1
    buffer_load_dwordx4 a[140:143], v8, s[32:35], s65 offen offset:3072 sc1
    s_add_u32 s65, s4, 11
    s_and_b32 s65, s65, 15
    s_lshl_b32 s65, s65, 12
    s_add_u32 s65, s65, s58
    buffer_load_dwordx4 a[144:147], v8, s[32:35], s65 offen offset:0 sc1
    buffer_load_dwordx4 a[148:151], v8, s[32:35], s65 offen offset:1024 sc1
    buffer_load_dwordx4 a[152:155], v8, s[32:35], s65 offen offset:2048 sc1
    buffer_load_dwordx4 a[156:159], v8, s[32:35], s65 offen offset:3072 sc1
    s_add_u32 s65, s4, 12
    s_and_b32 s65, s65, 15
    s_lshl_b32 s65, s65, 12
    s_add_u32 s65, s65, s58
    buffer_load_dwordx4 a[160:163], v8, s[32:35], s65 offen offset:0 sc1
    buffer_load_dwordx4 a[164:167], v8, s[32:35], s65 offen offset:1024 sc1
    buffer_load_dwordx4 a[168:171], v8, s[32:35], s65 offen offset:2048 sc1
    buffer_load_dwordx4 a[172:175], v8, s[32:35], s65 offen offset:3072 sc1
    s_add_u32 s65, s4, 13
    s_and_b32 s65, s65, 15
    s_lshl_b32 s65, s65, 12
    s_add_u32 s65, s65, s58
    buffer_load_dwordx4 a[176:179], v8, s[32:35], s65 offen offset:0 sc1
    buffer_load_dwordx4 a[180:183], v8, s[32:35], s65 offen offset:1024 sc1
    buffer_load_dwordx4 a[184:187], v8, s[32:35], s65 offen offset:2048 sc1
    buffer_load_dwordx4 a[188:191], v8, s[32:35], s65 offen offset:3072 sc1
    s_add_u32 s65, s4, 14
    s_and_b32 s65, s65, 15
    s_lshl_b32 s65, s65, 12
    s_add_u32 s65, s65, s58
    buffer_load_dwordx4 a[192:195], v8, s[32:35], s65 offen offset:0 sc1
    buffer_load_dwordx4 a[196:199], v8, s[32:35], s65 offen offset:1024 sc1
    buffer_load_dwordx4 a[200:203], v8, s[32:35], s65 offen offset:2048 sc1
    buffer_load_dwordx4 a[204:207], v8, s[32:35], s65 offen offset:3072 sc1
    s_add_u32 s65, s4, 15
    s_and_b32 s65, s65, 15
    s_lshl_b32 s65, s65, 12
    s_add_u32 s65, s65, s58
    buffer_load_dwordx4 a[208:211], v8, s[32:35], s65 offen offset:0 sc1
    buffer_load_dwordx4 a[212:215], v8, s[32:35], s65 offen offset:1024 sc1
    buffer_load_dwordx4 a[216:219], v8, s[32:35], s65 offen offset:2048 sc1
    buffer_load_dwordx4 a[220:223], v8, s[32:35], s65 offen offset:3072 sc1
    s_cmp_lg_u32 s40, 0
    s_cbranch_scc1 L_poll1_done
    s_lshl_b32 s43, s50, 1
    s_add_u32 s43, s43, s5
    s_lshl_b32 s43, s43, 7
    s_add_u32 s43, s43, 10485760
    v_and_b32 v31, 15, v1
    v_lshlrev_b32 v31, 2, v31
    s_mov_b32 s55, 0
L_poll1:
    buffer_load_dword v30, v31, s[32:35], s43 offen sc1
    s_waitcnt vmcnt(0)
    v_cmp_ne_u32 vcc, s6, v30
    s_add_u32 s55, s55, 1
    s_nop 3
    s_cbranch_vccz L_poll1_done
    s_sleep 2
    s_cmp_lt_u32 s55, 200000
    s_cbranch_scc1 L_poll1
L_poll1_done:
    s_barrier
    s_lshl_b32 s53, s50, 5
    s_lshl_b32 s43, s5, 4
    s_add_u32 s53, s53, s43
    s_lshl_b32 s43, s40, 2
    s_add_u32 s53, s53, s43
    s_mul_i32 s53, s53, 24576
    s_mul_i32 s43, s51, 3072
    s_add_u32 s53, s53, s43
    s_add_u32 s43, s4, 0
    s_and_b32 s43, s43, 15
    s_mul_i32 s43, s43, 6144
    s_add_u32 s43, s43, s53
    buffer_load_dwordx4 v[32:35], v8, s[32:35], s43 offen offset:0 sc1
    buffer_load_dwordx4 v[36:39], v8, s[32:35], s43 offen offset:1024 sc1
    buffer_load_dwordx4 v[40:43], v8, s[32:35], s43 offen offset:2048 sc1
    s_add_u32 s43, s4, 1
    s_and_b32 s43, s43, 15
    s_mul_i32 s43, s43, 6144
    s_add_u32 s43, s43, s53
    buffer_load_dwordx4 v[44:47], v8, s[32:35], s43 offen offset:0 sc1
    buffer_load_dwordx4 v[48:51], v8, s[32:35], s43 offen offset:1024 sc1
    buffer_load_dwordx4 v[52:55], v8, s[32:35], s43 offen offset:2048 sc1
    s_add_u32 s43, s4, 2
    s_and_b32 s43, s43, 15
    s_mul_i32 s43, s43, 6144
    s_add_u32 s43, s43, s53
    buffer_load_dwordx4 v[56:59], v8, s[32:35], s43 offen offset:0 sc1
    buffer_load_dwordx4 v[60:63], v8, s[32:35], s43 offen offset:1024 sc1
    buffer_load_dwordx4 v[64:67], v8, s[32:35], s43 offen offset:2048 sc1
    s_add_u32 s43, s4, 3
    s_and_b32 s43, s43, 15
    s_mul_i32 s43, s43, 6144
    s_add_u32 s43, s43, s53
    buffer_load_dwordx4 v[68:71], v8, s[32:35], s43 offen offset:0 sc1
    buffer_load_dwordx4 v[72:75], v8, s[32:35], s43 offen offset:1024 sc1
    buffer_load_dwordx4 v[76:79], v8, s[32:35], s43 offen offset:2048 sc1
    s_add_u32 s43, s4, 4
    s_and_b32 s43, s43, 15
    s_mul_i32 s43, s43, 6144
    s_add_u32 s43, s43, s53
    buffer_load_dwordx4 v[80:83], v8, s[32:35], s43 offen offset:0 sc1
    buffer_load_dwordx4 v[84:87], v8, s[32:35], s43 offen offset:1024 sc1
    buffer_load_dwordx4 v[88:91], v8, s[32:35], s43 offen offset:2048 sc1
    s_waitcnt vmcnt(12)
    v_mfma_f32_16x16x32_bf16 v[200:203], a[224:227], v[32:35], 0
    v_mfma_f32_16x16x32_bf16 v[212:215], a[228:231], v[32:35], 0
    v_mfma_f32_16x16x32_bf16 v[224:227], a[232:235], v[32:35], 0
    v_mfma_f32_16x16x32_bf16 v[236:239], a[236:239], v[32:35], 0
    s_add_u32 s43, s4, 5
    s_and_b32 s43, s43, 15
    s_mul_i32 s43, s43, 6144
    s_add_u32 s43, s43, s53
    buffer_load_dwordx4 v[92:95], v8, s[32:35], s43 offen offset:0 sc1
    buffer_load_dwordx4 v[96:99], v8, s[32:35], s43 offen offset:1024 sc1
    buffer_load_dwordx4 v[100:103], v8, s[32:35], s43 offen offset:2048 sc1
    v_mfma_f32_16x16x32_bf16 v[204:207], a[224:227], v[36:39], 0
    v_mfma_f32_16x16x32_bf16 v[216:219], a[228:231], v[36:39], 0
    v_mfma_f32_16x16x32_bf16 v[228:231], a[232:235], v[36:39], 0
    v_mfma_f32_16x16x32_bf16 v[240:243], a[236:239], v[36:39], 0
    v_mfma_f32_16x16x32_bf16 v[208:211], a[224:227], v[40:43], 0
    v_mfma_f32_16x16x32_bf16 v[220:223], a[228:231], v[40:43], 0
    v_mfma_f32_16x16x32_bf16 v[232:235], a[232:235], v[40:43], 0
    v_mfma_f32_16x16x32_bf16 v[244:247], a[236:239], v[40:43], 0
    s_waitcnt vmcnt(12)
    v_mfma_f32_16x16x32_bf16 v[200:203], a[240:243], v[44:47], v[200:203]
    v_mfma_f32_16x16x32_bf16 v[212:215], a[244:247], v[44:47], v[212:215]
    v_mfma_f32_16x16x32_bf16 v[224:227], a[248:251], v[44:47], v[224:227]
    v_mfma_f32_16x16x32_bf16 v[236:239], a[252:255], v[44:47], v[236:239]
    s_add_u32 s43, s4, 6
    s_and_b32 s43, s43, 15
    s_mul_i32 s43, s43, 6144
    s_add_u32 s43, s43, s53
    buffer_load_dwordx4 v[104:107], v8, s[32:35], s43 offen offset:0 sc1
    buffer_load_dwordx4 v[108:111], v8, s[32:35], s43 offen offset:1024 sc1
    buffer_load_dwordx4 v[112:115], v8, s[32:35], s43 offen offset:2048 sc1
    v_mfma_f32_16x16x32_bf16 v[204:207], a[240:243], v[48:51], v[204:207]
    v_mfma_f32_16x16x32_bf16 v[216:219], a[244:247], v[48:51], v[216:219]
    v_mfma_f32_16x16x32_bf16 v[228:231], a[248:251], v[48:51], v[228:231]
    v_mfma_f32_16x16x32_bf16 v[240:243], a[252:255], v[48:51], v[240:243]
    v_mfma_f32_16x16x32_bf16 v[208:211], a[240:243], v[52:55], v[208:211]
    v_mfma_f32_16x16x32_bf16 v[220:223], a[244:247], v[52:55], v[220:223]
    v_mfma_f32_16x16x32_bf16 v[232:235], a[248:251], v[52:55], v[232:235]
    v_mfma_f32_16x16x32_bf16 v[244:247], a[252:255], v[52:55], v[244:247]
    s_waitcnt vmcnt(12)
    v_mfma_f32_16x16x32_bf16 v[200:203], a[0:3], v[56:59], v[200:203]
    v_mfma_f32_16x16x32_bf16 v[212:215], a[4:7], v[56:59], v[212:215]
    v_mfma_f32_16x16x32_bf16 v[224:227], a[8:11], v[56:59], v[224:227]
    v_mfma_f32_16x16x32_bf16 v[236:239], a[12:15], v[56:59], v[236:239]
    s_add_u32 s43, s4, 7
    s_and_b32 s43, s43, 15
    s_mul_i32 s43, s43, 6144
    s_add_u32 s43, s43, s53
    buffer_load_dwordx4 v[116:119], v8, s[32:35], s43 offen offset:0 sc1
    buffer_load_dwordx4 v[120:123], v8, s[32:35], s43 offen offset:1024 sc1
    buffer_load_dwordx4 v[124:127], v8, s[32:35], s43 offen offset:2048 sc1
    v_mfma_f32_16x16x32_bf16 v[204:207], a[0:3], v[60:63], v[204:207]
    v_mfma_f32_16x16x32_bf16 v[216:219], a[4:7], v[60:63], v[216:219]
    v_mfma_f32_16x16x32_bf16 v[228:231], a[8:11], v[60:63], v[228:231]
    v_mfma_f32_16x16x32_bf16 v[240:243], a[12:15], v[60:63], v[240:243]
    v_mfma_f32_16x16x32_bf16 v[208:211], a[0:3], v[64:67], v[208:211]
    v_mfma_f32_16x16x32_bf16 v[220:223], a[4:7], v[64:67], v[220:223]
    v_mfma_f32_16x16x32_bf16 v[232:235], a[8:11], v[64:67], v[232:235]
    v_mfma_f32_16x16x32_bf16 v[244:247], a[12:15], v[64:67], v[244:247]
    s_waitcnt vmcnt(12)
    v_mfma_f32_16x16x32_bf16 v[200:203], a[16:19], v[68:71], v[200:203]
    v_mfma_f32_16x16x32_bf16 v[212:215], a[20:23], v[68:71], v[212:215]
    v_mfma_f32_16x16x32_bf16 v[224:227], a[24:27], v[68:71], v[224:227]
    v_mfma_f32_16x16x32_bf16 v[236:239], a[28:31], v[68:71], v[236:239]
    s_add_u32 s43, s4, 8
    s_and_b32 s43, s43, 15
    s_mul_i32 s43, s43, 6144
    s_add_u32 s43, s43, s53
    buffer_load_dwordx4 v[128:131], v8, s[32:35], s43 offen offset:0 sc1
    buffer_load_dwordx4 v[132:135], v8, s[32:35], s43 offen offset:1024 sc1
    buffer_load_dwordx4 v[136:139], v8, s[32:35], s43 offen offset:2048 sc1
    v_mfma_f32_16x16x32_bf16 v[204:207], a[16:19], v[72:75], v[204:207]
    v_mfma_f32_16x16x32_bf16 v[216:219], a[20:23], v[72:75], v[216:219]
    v_mfma_f32_16x16x32_bf16 v[228:231], a[24:27], v[72:75], v[228:231]
    v_mfma_f32_16x16x32_bf16 v[240:243], a[28:31], v[72:75], v[240:243]
    v_mfma_f32_16x16x32_bf16 v[208:211], a[16:19], v[76:79], v[208:211]
    v_mfma_f32_16x16x32_bf16 v[220:223], a[20:23], v[76:79], v[220:223]
    v_mfma_f32_16x16x32_bf16 v[232:235], a[24:27], v[76:79], v[232:235]
    v_mfma_f32_16x16x32_bf16 v[244:247], a[28:31], v[76:79], v[244:247]
    s_waitcnt vmcnt(12)
    v_mfma_f32_16x16x32_bf16 v[200:203], a[32:35], v[80:83], v[200:203]
    v_mfma_f32_16x16x32_bf16 v[212:215], a[36:39], v[80:83], v[212:215]
    v_mfma_f32_16x16x32_bf16 v[224:227], a[40:43], v[80:83], v[224:227]
    v_mfma_f32_16x16x32_bf16 v[236:239], a[44:47], v[80:83], v[236:239]
    s_add_u32 s43, s4, 9
    s_and_b32 s43, s43, 15
    s_mul_i32 s43, s43, 6144
    s_add_u32 s43, s43, s53
    buffer_load_dwordx4 v[140:143], v8, s[32:35], s43 offen offset:0 sc1
    buffer_load_dwordx4 v[144:147], v8, s[32:35], s43 offen offset:1024 sc1
    buffer_load_dwordx4 v[148:151], v8, s[32:35], s43 offen offset:2048 sc1
    v_mfma_f32_16x16x32_bf16 v[204:207], a[32:35], v[84:87], v[204:207]
    v_mfma_f32_16x16x32_bf16 v[216:219], a[36:39], v[84:87], v[216:219]
    v_mfma_f32_16x16x32_bf16 v[228:231], a[40:43], v[84:87], v[228:231]
    v_mfma_f32_16x16x32_bf16 v[240:243], a[44:47], v[84:87], v[240:243]
    v_mfma_f32_16x16x32_bf16 v[208:211], a[32:35], v[88:91], v[208:211]
    v_mfma_f32_16x16x32_bf16 v[220:223], a[36:39], v[88:91], v[220:223]
    v_mfma_f32_16x16x32_bf16 v[232:235], a[40:43], v[88:91], v[232:235]
    v_mfma_f32_16x16x32_bf16 v[244:247], a[44:47], v[88:91], v[244:247]
    s_waitcnt vmcnt(12)
    v_mfma_f32_16x16x32_bf16 v[200:203], a[48:51], v[92:95], v[200:203]
    v_mfma_f32_16x16x32_bf16 v[212:215], a[52:55], v[92:95], v[212:215]
    v_mfma_f32_16x16x32_bf16 v[224:227], a[56:59], v[92:95], v[224:227]
    v_mfma_f32_16x16x32_bf16 v[236:239], a[60:63], v[92:95], v[236:239]
    s_add_u32 s43, s4, 10
    s_and_b32 s43, s43, 15
    s_mul_i32 s43, s43, 6144
    s_add_u32 s43, s43, s53
    buffer_load_dwordx4 v[152:155], v8, s[32:35], s43 offen offset:0 sc1
    buffer_load_dwordx4 v[156:159], v8, s[32:35], s43 offen offset:1024 sc1
    buffer_load_dwordx4 v[160:163], v8, s[32:35], s43 offen offset:2048 sc1
    v_mfma_f32_16x16x32_bf16 v[204:207], a[48:51], v[96:99], v[204:207]
    v_mfma_f32_16x16x32_bf16 v[216:219], a[52:55], v[96:99], v[216:219]
    v_mfma_f32_16x16x32_bf16 v[228:231], a[56:59], v[96:99], v[228:231]
    v_mfma_f32_16x16x32_bf16 v[240:243], a[60:63], v[96:99], v[240:243]
    v_mfma_f32_16x16x32_bf16 v[208:211], a[48:51], v[100:103], v[208:211]
    v_mfma_f32_16x16x32_bf16 v[220:223], a[52:55], v[100:103], v[220:223]
    v_mfma_f32_16x16x32_bf16 v[232:235], a[56:59], v[100:103], v[232:235]
    v_mfma_f32_16x16x32_bf16 v[244:247], a[60:63], v[100:103], v[244:247]
    s_waitcnt vmcnt(12)
    v_mfma_f32_16x16x32_bf16 v[200:203], a[64:67], v[104:107], v[200:203]
    v_mfma_f32_16x16x32_bf16 v[212:215], a[68:71], v[104:107], v[212:215]
    v_mfma_f32_16x16x32_bf16 v[224:227], a[72:75], v[104:107], v[224:227]
    v_mfma_f32_16x16x32_bf16 v[236:239], a[76:79], v[104:107], v[236:239]
    s_add_u32 s43, s4, 11
    s_and_b32 s43, s43, 15
    s_mul_i32 s43, s43, 6144
    s_add_u32 s43, s43, s53
    buffer_load_dwordx4 v[164:167], v8, s[32:35], s43 offen offset:0 sc1
    buffer_load_dwordx4 v[168:171], v8, s[32:35], s43 offen offset:1024 sc1
    buffer_load_dwordx4 v[172:175], v8, s[32:35], s43 offen offset:2048 sc1
    v_mfma_f32_16x16x32_bf16 v[204:207], a[64:67], v[108:111], v[204:207]
    v_mfma_f32_16x16x32_bf16 v[216:219], a[68:71], v[108:111], v[216:219]
    v_mfma_f32_16x16x32_bf16 v[228:231], a[72:75], v[108:111], v[228:231]
    v_mfma_f32_16x16x32_bf16 v[240:243], a[76:79], v[108:111], v[240:243]
    v_mfma_f32_16x16x32_bf16 v[208:211], a[64:67], v[112:115], v[208:211]
    v_mfma_f32_16x16x32_bf16 v[220:223], a[68:71], v[112:115], v[220:223]
    v_mfma_f32_16x16x32_bf16 v[232:235], a[72:75], v[112:115], v[232:235]
    v_mfma_f32_16x16x32_bf16 v[244:247], a[76:79], v[112:115], v[244:247]
    s_waitcnt vmcnt(12)
    v_mfma_f32_16x16x32_bf16 v[200:203], a[80:83], v[116:119], v[200:203]
    v_mfma_f32_16x16x32_bf16 v[212:215], a[84:87], v[116:119], v[212:215]
    v_mfma_f32_16x16x32_bf16 v[224:227], a[88:91], v[116:119], v[224:227]
    v_mfma_f32_16x16x32_bf16 v[236:239], a[92:95], v[116:119], v[236:239]
    s_add_u32 s43, s4, 12
    s_and_b32 s43, s43, 15
    s_mul_i32 s43, s43, 6144
    s_add_u32 s43, s43, s53
    buffer_load_dwordx4 v[176:179], v8, s[32:35], s43 offen offset:0 sc1
    buffer_load_dwordx4 v[180:183], v8, s[32:35], s43 offen offset:1024 sc1
    buffer_load_dwordx4 v[184:187], v8, s[32:35], s43 offen offset:2048 sc1
    v_mfma_f32_16x16x32_bf16 v[204:207], a[80:83], v[120:123], v[204:207]
    v_mfma_f32_16x16x32_bf16 v[216:219], a[84:87], v[120:123], v[216:219]
    v_mfma_f32_16x16x32_bf16 v[228:231], a[88:91], v[120:123], v[228:231]
    v_mfma_f32_16x16x32_bf16 v[240:243], a[92:95], v[120:123], v[240:243]
    v_mfma_f32_16x16x32_bf16 v[208:211], a[80:83], v[124:127], v[208:211]
    v_mfma_f32_16x16x32_bf16 v[220:223], a[84:87], v[124:127], v[220:223]
    v_mfma_f32_16x16x32_bf16 v[232:235], a[88:91], v[124:127], v[232:235]
    v_mfma_f32_16x16x32_bf16 v[244:247], a[92:95], v[124:127], v[244:247]
    s_waitcnt vmcnt(12)
    v_mfma_f32_16x16x32_bf16 v[200:203], a[96:99], v[128:131], v[200:203]
    v_mfma_f32_16x16x32_bf16 v[212:215], a[100:103], v[128:131], v[212:215]
    v_mfma_f32_16x16x32_bf16 v[224:227], a[104:107], v[128:131], v[224:227]
    v_mfma_f32_16x16x32_bf16 v[236:239], a[108:111], v[128:131], v[236:239]
    s_add_u32 s43, s4, 13
    s_and_b32 s43, s43, 15
    s_mul_i32 s43, s43, 6144
    s_add_u32 s43, s43, s53
    buffer_load_dwordx4 v[188:191], v8, s[32:35], s43 offen offset:0 sc1
    buffer_load_dwordx4 v[192:195], v8, s[32:35], s43 offen offset:1024 sc1
    buffer_load_dwordx4 v[196:199], v8, s[32:35], s43 offen offset:2048 sc1
    v_mfma_f32_16x16x32_bf16 v[204:207], a[96:99], v[132:135], v[204:207]
    v_mfma_f32_16x16x32_bf16 v[216:219], a[100:103], v[132:135], v[216:219]
    v_mfma_f32_16x16x32_bf16 v[228:231], a[104:107], v[132:135], v[228:231]
    v_mfma_f32_16x16x32_bf16 v[240:243], a[108:111], v[132:135], v[240:243]
    v_mfma_f32_16x16x32_bf16 v[208:211], a[96:99], v[136:139], v[208:211]
    v_mfma_f32_16x16x32_bf16 v[220:223], a[100:103], v[136:139], v[220:223]
    v_mfma_f32_16x16x32_bf16 v[232:235], a[104:107], v[136:139], v[232:235]
    v_mfma_f32_16x16x32_bf16 v[244:247], a[108:111], v[136:139], v[244:247]
    s_waitcnt vmcnt(12)
    v_mfma_f32_16x16x32_bf16 v[200:203], a[112:115], v[140:143], v[200:203]
    v_mfma_f32_16x16x32_bf16 v[212:215], a[116:119], v[140:143], v[212:215]
    v_mfma_f32_16x16x32_bf16 v[224:227], a[120:123], v[140:143], v[224:227]
    v_mfma_f32_16x16x32_bf16 v[236:239], a[124:127], v[140:143], v[236:239]
    s_add_u32 s43, s4, 14
    s_and_b32 s43, s43, 15
    s_mul_i32 s43, s43, 6144
    s_add_u32 s43, s43, s53
    buffer_load_dwordx4 v[32:35], v8, s[32:35], s43 offen offset:0 sc1
    buffer_load_dwordx4 v[36:39], v8, s[32:35], s43 offen offset:1024 sc1
    buffer_load_dwordx4 v[40:43], v8, s[32:35], s43 offen offset:2048 sc1
    v_mfma_f32_16x16x32_bf16 v[204:207], a[112:115], v[144:147], v[204:207]
    v_mfma_f32_16x16x32_bf16 v[216:219], a[116:119], v[144:147], v[216:219]
    v_mfma_f32_16x16x32_bf16 v[228:231], a[120:123], v[144:147], v[228:231]
    v_mfma_f32_16x16x32_bf16 v[240:243], a[124:127], v[144:147], v[240:243]
    v_mfma_f32_16x16x32_bf16 v[208:211], a[112:115], v[148:151], v[208:211]
    v_mfma_f32_16x16x32_bf16 v[220:223], a[116:119], v[148:151], v[220:223]
    v_mfma_f32_16x16x32_bf16 v[232:235], a[120:123], v[148:151], v[232:235]
    v_mfma_f32_16x16x32_bf16 v[244:247], a[124:127], v[148:151], v[244:247]
    s_waitcnt vmcnt(12)
    v_mfma_f32_16x16x32_bf16 v[200:203], a[128:131], v[152:155], v[200:203]
    v_mfma_f32_16x16x32_bf16 v[212:215], a[132:135], v[152:155], v[212:215]
    v_mfma_f32_16x16x32_bf16 v[224:227], a[136:139], v[152:155], v[224:227]
    v_mfma_f32_16x16x32_bf16 v[236:239], a[140:143], v[152:155], v[236:239]
    s_add_u32 s43, s4, 15
    s_and_b32 s43, s43, 15
    s_mul_i32 s43, s43, 6144
    s_add_u32 s43, s43, s53
    buffer_load_dwordx4 v[44:47], v8, s[32:35], s43 offen offset:0 sc1
    buffer_load_dwordx4 v[48:51], v8, s[32:35], s43 offen offset:1024 sc1
    buffer_load_dwordx4 v[52:55], v8, s[32:35], s43 offen offset:2048 sc1
    v_mfma_f32_16x16x32_bf16 v[204:207], a[128:131], v[156:159], v[204:207]
    v_mfma_f32_16x16x32_bf16 v[216:219], a[132:135], v[156:159], v[216:219]
    v_mfma_f32_16x16x32_bf16 v[228:231], a[136:139], v[156:159], v[228:231]
    v_mfma_f32_16x16x32_bf16 v[240:243], a[140:143], v[156:159], v[240:243]
    v_mfma_f32_16x16x32_bf16 v[208:211], a[128:131], v[160:163], v[208:211]
    v_mfma_f32_16x16x32_bf16 v[220:223], a[132:135], v[160:163], v[220:223]
    v_mfma_f32_16x16x32_bf16 v[232:235], a[136:139], v[160:163], v[232:235]
    v_mfma_f32_16x16x32_bf16 v[244:247], a[140:143], v[160:163], v[244:247]
    s_waitcnt vmcnt(12)
    v_mfma_f32_16x16x32_bf16 v[200:203], a[144:147], v[164:167], v[200:203]
    v_mfma_f32_16x16x32_bf16 v[212:215], a[148:151], v[164:167], v[212:215]
    v_mfma_f32_16x16x32_bf16 v[224:227], a[152:155], v[164:167], v[224:227]
    v_mfma_f32_16x16x32_bf16 v[236:239], a[156:159], v[164:167], v[236:239]
    v_mfma_f32_16x16x32_bf16 v[204:207], a[144:147], v[168:171], v[204:207]
    v_mfma_f32_16x16x32_bf16 v[216:219], a[148:151], v[168:171], v[216:219]
    v_mfma_f32_16x16x32_bf16 v[228:231], a[152:155], v[168:171], v[228:231]
    v_mfma_f32_16x16x32_bf16 v[240:243], a[156:159], v[168:171], v[240:243]
    v_mfma_f32_16x16x32_bf16 v[208:211], a[144:147], v[172:175], v[208:211]
    v_mfma_f32_16x16x32_bf16 v[220:223], a[148:151], v[172:175], v[220:223]
    v_mfma_f32_16x16x32_bf16 v[232:235], a[152:155], v[172:175], v[232:235]
    v_mfma_f32_16x16x32_bf16 v[244:247], a[156:159], v[172:175], v[244:247]
    s_waitcnt vmcnt(9)
    v_mfma_f32_16x16x32_bf16 v[200:203], a[160:163], v[176:179], v[200:203]
    v_mfma_f32_16x16x32_bf16 v[212:215], a[164:167], v[176:179], v[212:215]
    v_mfma_f32_16x16x32_bf16 v[224:227], a[168:171], v[176:179], v[224:227]
    v_mfma_f32_16x16x32_bf16 v[236:239], a[172:175], v[176:179], v[236:239]
    v_mfma_f32_16x16x32_bf16 v[204:207], a[160:163], v[180:183], v[204:207]
    v_mfma_f32_16x16x32_bf16 v[216:219], a[164:167], v[180:183], v[216:219]
    v_mfma_f32_16x16x32_bf16 v[228:231], a[168:171], v[180:183], v[228:231]
    v_mfma_f32_16x16x32_bf16 v[240:243], a[172:175], v[180:183], v[240:243]
    v_mfma_f32_16x16x32_bf16 v[208:211], a[160:163], v[184:187], v[208:211]
    v_mfma_f32_16x16x32_bf16 v[220:223], a[164:167], v[184:187], v[220:223]
    v_mfma_f32_16x16x32_bf16 v[232:235], a[168:171], v[184:187], v[232:235]
    v_mfma_f32_16x16x32_bf16 v[244:247], a[172:175], v[184:187], v[244:247]
    s_waitcnt vmcnt(6)
    v_mfma_f32_16x16x32_bf16 v[200:203], a[176:179], v[188:191], v[200:203]
    v_mfma_f32_16x16x32_bf16 v[212:215], a[180:183], v[188:191], v[212:215]
    v_mfma_f32_16x16x32_bf16 v[224:227], a[184:187], v[188:191], v[224:227]
    v_mfma_f32_16x16x32_bf16 v[236:239], a[188:191], v[188:191], v[236:239]
    v_mfma_f32_16x16x32_bf16 v[204:207], a[176:179], v[192:195], v[204:207]
    v_mfma_f32_16x16x32_bf16 v[216:219], a[180:183], v[192:195], v[216:219]
    v_mfma_f32_16x16x32_bf16 v[228:231], a[184:187], v[192:195], v[228:231]
    v_mfma_f32_16x16x32_bf16 v[240:243], a[188:191], v[192:195], v[240:243]
    v_mfma_f32_16x16x32_bf16 v[208:211], a[176:179], v[196:199], v[208:211]
    v_mfma_f32_16x16x32_bf16 v[220:223], a[180:183], v[196:199], v[220:223]
    v_mfma_f32_16x16x32_bf16 v[232:235], a[184:187], v[196:199], v[232:235]
    v_mfma_f32_16x16x32_bf16 v[244:247], a[188:191], v[196:199], v[244:247]
    s_waitcnt vmcnt(3)
    v_mfma_f32_16x16x32_bf16 v[200:203], a[192:195], v[32:35], v[200:203]
    v_mfma_f32_16x16x32_bf16 v[212:215], a[196:199], v[32:35], v[212:215]
    v_mfma_f32_16x16x32_bf16 v[224:227], a[200:203], v[32:35], v[224:227]
    v_mfma_f32_16x16x32_bf16 v[236:239], a[204:207], v[32:35], v[236:239]
    v_mfma_f32_16x16x32_bf16 v[204:207], a[192:195], v[36:39], v[204:207]
    v_mfma_f32_16x16x32_bf16 v[216:219], a[196:199], v[36:39], v[216:219]
    v_mfma_f32_16x16x32_bf16 v[228:231], a[200:203], v[36:39], v[228:231]
    v_mfma_f32_16x16x32_bf16 v[240:243], a[204:207], v[36:39], v[240:243]
    v_mfma_f32_16x16x32_bf16 v[208:211], a[192:195], v[40:43], v[208:211]
    v_mfma_f32_16x16x32_bf16 v[220:223], a[196:199], v[40:43], v[220:223]
    v_mfma_f32_16x16x32_bf16 v[232:235], a[200:203], v[40:43], v[232:235]
    v_mfma_f32_16x16x32_bf16 v[244:247], a[204:207], v[40:43], v[244:247]
    s_waitcnt vmcnt(0)
    v_mfma_f32_16x16x32_bf16 v[200:203], a[208:211], v[44:47], v[200:203]
    v_mfma_f32_16x16x32_bf16 v[212:215], a[212:215], v[44:47], v[212:215]
    v_mfma_f32_16x16x32_bf16 v[224:227], a[216:219], v[44:47], v[224:227]
    v_mfma_f32_16x16x32_bf16 v[236:239], a[220:223], v[44:47], v[236:239]
    v_mfma_f32_16x16x32_bf16 v[204:207], a[208:211], v[48:51], v[204:207]
    v_mfma_f32_16x16x32_bf16 v[216:219], a[212:215], v[48:51], v[216:219]
    v_mfma_f32_16x16x32_bf16 v[228:231], a[216:219], v[48:51], v[228:231]
    v_mfma_f32_16x16x32_bf16 v[240:243], a[220:223], v[48:51], v[240:243]
    v_mfma_f32_16x16x32_bf16 v[208:211], a[208:211], v[52:55], v[208:211]
    v_mfma_f32_16x16x32_bf16 v[220:223], a[212:215], v[52:55], v[220:223]
    v_mfma_f32_16x16x32_bf16 v[232:235], a[216:219], v[52:55], v[232:235]
    v_mfma_f32_16x16x32_bf16 v[244:247], a[220:223], v[52:55], v[244:247]
    s_nop 7
    s_mul_i32 s44, s40, 12288
    v_add_u32 v30, s44, v8
    ds_write_b128 v30, v[200:203] offset:0
    ds_write_b128 v30, v[204:207] offset:1024
    ds_write_b128 v30, v[208:211] offset:2048
    ds_write_b128 v30, v[212:215] offset:3072
    ds_write_b128 v30, v[216:219] offset:4096
    ds_write_b128 v30, v[220:223] offset:5120
    ds_write_b128 v30, v[224:227] offset:6144
    ds_write_b128 v30, v[228:231] offset:7168
    ds_write_b128 v30, v[232:235] offset:8192
    ds_write_b128 v30, v[236:239] offset:9216
    ds_write_b128 v30, v[240:243] offset:10240
    ds_write_b128 v30, v[244:247] offset:11264
    s_waitcnt lgkmcnt(0)
    s_barrier
    s_mul_i32 s44, s40, 3072
    v_add_u32 v30, s44, v8
    ds_read_b128 v[32:35], v30 offset:0
    ds_read_b128 v[36:39], v30 offset:1024
    ds_read_b128 v[40:43], v30 offset:2048
    ds_read_b128 v[44:47], v30 offset:12288
    ds_read_b128 v[48:51], v30 offset:13312
    ds_read_b128 v[52:55], v30 offset:14336
    ds_read_b128 v[56:59], v30 offset:24576
    ds_read_b128 v[60:63], v30 offset:25600
    ds_read_b128 v[64:67], v30 offset:26624
    ds_read_b128 v[68:71], v30 offset:36864
    ds_read_b128 v[72:75], v30 offset:37888
    ds_read_b128 v[76:79], v30 offset:38912
    s_waitcnt lgkmcnt(0)
    v_pk_add_f32 v[32:33], v[32:33], v[44:45]
    v_pk_add_f32 v[56:57], v[56:57], v[68:69]
    v_pk_add_f32 v[32:33], v[32:33], v[56:57]
    v_pk_add_f32 v[34:35], v[34:35], v[46:47]
    v_pk_add_f32 v[58:59], v[58:59], v[70:71]
    v_pk_add_f32 v[34:35], v[34:35], v[58:59]
    v_pk_add_f32 v[36:37], v[36:37], v[48:49]
    v_pk_add_f32 v[60:61], v[60:61], v[72:73]
    v_pk_add_f32 v[36:37], v[36:37], v[60:61]
    v_pk_add_f32 v[38:39], v[38:39], v[50:51]
    v_pk_add_f32 v[62:63], v[62:63], v[74:75]
    v_pk_add_f32 v[38:39], v[38:39], v[62:63]
    v_pk_add_f32 v[40:41], v[40:41], v[52:53]
    v_pk_add_f32 v[64:65], v[64:65], v[76:77]
    v_pk_add_f32 v[40:41], v[40:41], v[64:65]
    v_pk_add_f32 v[42:43], v[42:43], v[54:55]
    v_pk_add_f32 v[66:67], v[66:67], v[78:79]
    v_pk_add_f32 v[42:43], v[42:43], v[66:67]
    s_lshr_b32 s43, s40, 1
    s_and_b32 s45, s40, 1
    s_lshl_b32 s45, s45, 12
    s_cmp_eq_u32 s43, s5
    s_cbranch_scc1 L_recv
    s_lshl_b32 s44, s2, 13
    s_add_u32 s44, s44, s45
    s_add_u32 s44, s44, 8388608
    v_mov_b32 v80, v32
    v_mov_b32 v81, v33
    v_mov_b32 v82, v34
    v_mov_b32 v83, s6
    buffer_store_dwordx4 v[80:83], v8, s[32:35], s44 offen offset:0 sc1
    v_mov_b32 v84, v35
    v_mov_b32 v85, v36
    v_mov_b32 v86, v37
    v_mov_b32 v87, s6
    buffer_store_dwordx4 v[84:87], v8, s[32:35], s44 offen offset:1024 sc1
    v_mov_b32 v88, v38
    v_mov_b32 v89, v39
    v_mov_b32 v90, v40
    v_mov_b32 v91, s6
    buffer_store_dwordx4 v[88:91], v8, s[32:35], s44 offen offset:2048 sc1
    v_mov_b32 v92, v41
    v_mov_b32 v93, v42
    v_mov_b32 v94, v43
    v_mov_b32 v95, s6
    buffer_store_dwordx4 v[92:95], v8, s[32:35], s44 offen offset:3072 sc1
    s_branch L_fin
L_recv:
    s_xor_b32 s46, s2, 1
    s_lshl_b32 s46, s46, 13
    s_add_u32 s46, s46, s45
    s_add_u32 s46, s46, 8388608
    s_mul_i32 s43, s50, 96
    s_mul_i32 s44, s51, 48
    s_add_u32 s43, s43, s44
    s_lshl_b32 s43, s43, 10
    s_lshl_b32 s44, s52, 7
    s_add_u32 s43, s43, s44
    s_lshl_b32 s44, s40, 5
    s_add_u32 s43, s43, s44
    v_and_b32 v31, 15, v1
    v_lshlrev_b32 v31, 10, v31
    v_lshrrev_b32 v2, 4, v1
    v_lshl_add_u32 v31, v2, 3, v31
    s_mov_b32 s55, 0
L_poll2:
    buffer_load_dwordx4 v[80:83], v8, s[32:35], s46 offen offset:0 sc1
    buffer_load_dwordx4 v[84:87], v8, s[32:35], s46 offen offset:1024 sc1
    buffer_load_dwordx4 v[88:91], v8, s[32:35], s46 offen offset:2048 sc1
    buffer_load_dwordx4 v[92:95], v8, s[32:35], s46 offen offset:3072 sc1
    s_waitcnt vmcnt(0)
    v_xor_b32 v2, v83, v87
    v_xor_b32 v3, v91, v95
    v_xor_b32 v4, s6, v83
    v_xor_b32 v5, v87, v91
    v_or_b32 v2, v2, v3
    v_or3_b32 v2, v2, v4, v5
    v_cmp_ne_u32 vcc, 0, v2
    s_add_u32 s55, s55, 1
    s_nop 3
    s_cbranch_vccz L_poll2_done
    s_sleep 1
    s_cmp_lt_u32 s55, 200000
    s_cbranch_scc1 L_poll2
L_poll2_done:
    v_add_f32 v32, v32, v80
    v_add_f32 v33, v33, v81
    v_add_f32 v34, v34, v82
    v_add_f32 v35, v35, v84
    v_add_f32 v36, v36, v85
    v_add_f32 v37, v37, v86
    v_add_f32 v38, v38, v88
    v_add_f32 v39, v39, v89
    v_add_f32 v40, v40, v90
    v_add_f32 v41, v41, v92
    v_add_f32 v42, v42, v93
    v_add_f32 v43, v43, v94
    v_cvt_pk_bf16_f32 v64, v32, v33
    v_cvt_pk_bf16_f32 v65, v34, v35
    buffer_store_dwordx2 v[64:65], v31, s[28:31], s43 offen
    s_add_u32 s43, s43, 16384
    v_cvt_pk_bf16_f32 v66, v36, v37
    v_cvt_pk_bf16_f32 v67, v38, v39
    buffer_store_dwordx2 v[66:67], v31, s[28:31], s43 offen
    s_add_u32 s43, s43, 16384
    v_cvt_pk_bf16_f32 v68, v40, v41
    v_cvt_pk_bf16_f32 v69, v42, v43
    buffer_store_dwordx2 v[68:69], v31, s[28:31], s43 offen
    s_add_u32 s43, s43, 16384
L_fin:
L_end:
    s_endpgm
.section .rodata,"a"
.p2align 6
.amdhsa_kernel standalone__gqa_block_cached__near_ridge_kernel
  .amdhsa_next_free_vgpr 512
  .amdhsa_next_free_sgpr 102
  .amdhsa_accum_offset 256
  .amdhsa_group_segment_fixed_size 0
  .amdhsa_kernarg_size 64
  .amdhsa_user_sgpr_count 2
  .amdhsa_user_sgpr_kernarg_segment_ptr 1
  .amdhsa_system_sgpr_workgroup_id_x 1
.end_amdhsa_kernel
```
